```python
import torch

def _softmax(x, axis=-1):
    return torch.softmax(x, dim=axis)
def _gelu(x):
    return torch.nn.functional.gelu(x, approximate="tanh")
def _silu(x):
    return torch.nn.functional.silu(x)
def _sigmoid(x):
    return torch.sigmoid(x)
def _layernorm(x, axis=-1, eps=1e-5):
    m = x.mean(dim=axis, keepdim=True)
    v = x.var(dim=axis, keepdim=True, unbiased=False)
    return (x - m) / torch.sqrt(v + eps)
def _scatter_add(tgt, idx, src, axis=0):
    return tgt.clone().index_add_(axis, idx, src)
def _segment_sum(src, seg, n):
    out = torch.zeros((n,) + src.shape[1:], dtype=src.dtype)
    return out.index_add_(0, seg, src)
def _pad(x, pw):
    flat = tuple(v for pair in reversed(pw) for v in pair)
    return torch.nn.functional.pad(x, flat)

kernel_name = 'standalone__mha_softmax__near_ridge'

def setup_inputs():

    _w = (lambda a: (lambda t: t.to(torch.bfloat16) if t.is_floating_point() else t)(torch.as_tensor(a)))
    B, H, Sq, Sk, D = 8, 32, 368, 1024, 128
    return {
        "q": _w((lambda *s: torch.randn(*s, dtype=torch.bfloat16) * 0.8)(B, H, Sq, D)),
        "k": _w((lambda *s: torch.randn(*s, dtype=torch.bfloat16) * 0.8)(B, H, Sk, D)),
        "v": _w((lambda *s: torch.randn(*s, dtype=torch.bfloat16) * 0.05)(B, H, Sk, D)),
    }

def reference(q, k, v):
    scale = q.shape[-1] ** -0.5
    scores = torch.einsum("bhqd,bhkd->bhqk", q, k) * scale
    p = _softmax(scores, axis=-1)
    return torch.einsum("bhqk,bhkd->bhqd", p, v)
```

```asm
; @launch grid=(256,1,1) block=(256,1,1) lds=154176
.amdgcn_target "amdgcn-amd-amdhsa--gfx950"
.text
.globl standalone__mha_softmax__near_ridge_kernel
.p2align 8
.type standalone__mha_softmax__near_ridge_kernel,@function
standalone__mha_softmax__near_ridge_kernel:
    s_cmp_ge_u32 s2, 256
    s_cbranch_scc1 L_end
    s_load_dwordx8 s[4:11], s[0:1], 0
    v_and_b32 v20, 63, v0
    v_lshrrev_b32 v14, 6, v0
    v_lshrrev_b32 v16, 4, v20
    v_readfirstlane_b32 s49, v14
    v_and_b32 v17, 15, v20
    v_lshlrev_b32 v18, 9, v14
    v_lshl_add_u32 v18, v16, 11, v18
    v_lshl_add_u32 v2, v17, 4, v18
    v_mul_u32_u24 v18, 24576, v14
    v_lshl_add_u32 v18, v16, 8, v18
    v_xor_b32 v19, v17, v16
    v_lshl_add_u32 v15, v19, 4, v18
    s_mul_i32 s59, s49, 17408
    s_mul_i32 s36, s49, 2112
    s_add_u32 s37, s36, 50688
    s_mov_b32 s53, 0
    s_mov_b32 s54, 4096
    s_mov_b32 s55, 8192
    s_mov_b32 s56, 12288
    s_mov_b32 s57, 16384
    s_mov_b32 s58, 20480
    s_mul_i32 s3, s2, 13
    s_lshr_b32 s42, s2, 5
    s_mul_i32 s42, s42, 7
    s_add_u32 s3, s3, s42
    s_and_b32 s3, s3, 31
    s_lshl_b32 s3, s3, 13
    s_mul_i32 s42, s2, 94208
    s_lshl_b32 s43, s2, 18
    s_mov_b32 s18, 94208
    s_mov_b32 s19, 0x20000
    s_mov_b32 s30, 94208
    s_mov_b32 s31, 0x20000
    s_mov_b32 s22, 262144
    s_mov_b32 s23, 0x20000
    s_mov_b32 s26, 262144
    s_mov_b32 s27, 0x20000
    s_waitcnt lgkmcnt(0)
    s_add_u32 s20, s6, s43
    s_addc_u32 s21, s7, 0
    s_add_u32 s16, s4, s42
    s_addc_u32 s17, s5, 0
    s_add_u32 s24, s8, s43
    s_addc_u32 s25, s9, 0
    s_add_u32 s28, s10, s42
    s_addc_u32 s29, s11, 0
    s_add_u32 s42, s3, 0
    s_and_b32 s42, s42, 0x3ffff
    s_add_u32 m0, s36, 0
    s_nop 0
    buffer_load_dwordx4 v2, s[20:23], s42 offen offset:0 nt lds
    s_add_u32 m0, s36, 800
    s_nop 0
    buffer_load_dwordx4 v2, s[20:23], s42 offen offset:256 nt lds
    s_add_u32 s42, s3, 8192
    s_and_b32 s42, s42, 0x3ffff
    s_add_u32 m0, s36, 8448
    s_nop 0
    buffer_load_dwordx4 v2, s[20:23], s42 offen offset:0 nt lds
    s_add_u32 m0, s36, 9248
    s_nop 0
    buffer_load_dwordx4 v2, s[20:23], s42 offen offset:256 nt lds
    s_add_u32 s42, s3, 0
    s_and_b32 s42, s42, 0x3ffff
    s_add_u32 m0, s37, 0
    s_nop 0
    buffer_load_dwordx4 v2, s[24:27], s42 offen offset:0 nt lds
    s_add_u32 m0, s37, 800
    s_nop 0
    buffer_load_dwordx4 v2, s[24:27], s42 offen offset:256 nt lds
    s_add_u32 m0, s59, 84480
    s_nop 0
    buffer_load_dwordx4 v15, s[16:19], s53 offen offset:0 nt lds
    s_add_u32 m0, s59, 84544
    s_nop 0
    buffer_load_dwordx4 v15, s[16:19], s53 offen offset:1024 nt lds
    s_add_u32 m0, s59, 84608
    s_nop 0
    buffer_load_dwordx4 v15, s[16:19], s53 offen offset:2048 nt lds
    s_add_u32 m0, s59, 84672
    s_nop 0
    buffer_load_dwordx4 v15, s[16:19], s53 offen offset:3072 nt lds
    s_getreg_b32 s39, hwreg(HW_REG_HW_ID, 13, 2)
    s_getreg_b32 s38, hwreg(HW_REG_HW_ID, 8, 2)
    s_lshl2_add_u32 s39, s38, s39
    v_lshrrev_b32 v21, 4, v0
    v_lshlrev_b32 v21, 4, v21
    v_add_lshl_u32 v21, v21, s39, 7
    v_cmp_lt_u32 vcc, L_proend-L_pf+127, v21
    v_add_u32 v22, L_loop-L_proend-256, v21
    s_getpc_b64 s[44:45]
L_pf:
    v_cndmask_b32 v21, v21, v22, vcc
    v_min_u32 v21, L_lloop-L_pf, v21
    global_load_dword v155, v21, s[44:45]
    v_mul_u32_u24 v7, 24576, v14
    v_lshrrev_b32 v23, 3, v20
    v_and_b32 v24, 7, v20
    v_lshl_add_u32 v7, v23, 8, v7
    v_lshl_add_u32 v7, v24, 4, v7
    v_lshrrev_b32 v19, 1, v16
    v_bfe_u32 v4, v20, 2, 3
    v_mul_u32_u24 v4, 1056, v4
    v_lshl_add_u32 v4, v19, 8, v4
    v_and_b32 v18, 3, v20
    v_lshl_add_u32 v4, v18, 3, v4
    v_add_u32 v4, 50688, v4
    v_and_b32 v3, 7, v20
    v_mul_u32_u24 v3, 1056, v3
    v_bfe_u32 v18, v20, 3, 1
    v_lshl_add_u32 v3, v18, 8, v3
    v_lshl_add_u32 v3, v16, 4, v3
    v_lshrrev_b32 v18, 2, v17
    v_mul_u32_u24 v152, 1088, v18
    v_and_b32 v18, 3, v17
    v_lshl_add_u32 v152, v18, 8, v152
    v_xor_b32 v18, v18, v16
    v_lshl_add_u32 v152, v18, 4, v152
    v_add_u32 v152, s59, v152
    v_add_u32 v152, 84480, v152
    v_mul_u32_u24 v18, 13056, v14
    v_add_u32 v18, 101376, v18
    v_mul_u32_u24 v19, 272, v23
    v_lshl_add_u32 v19, v24, 4, v19
    v_add_u32 v0, v18, v19
    v_mul_u32_u24 v19, 272, v17
    v_lshl_add_u32 v19, v16, 3, v19
    v_add_u32 v1, v18, v19
    s_mov_b32 s40, 0x3e0293ee
    s_mov_b32 s41, 0x3e0293ee
    s_mov_b32 s48, 0xffff0000
    s_mov_b32 s50, 0
    v_mov_b32 v156, 0
    v_mov_b32 v157, 0
    v_mov_b32 v158, 0
    v_mov_b32 v159, 0
    v_mov_b32 v8, 0
    v_mov_b32 v9, 0
    v_mov_b32 v10, 0
    v_mov_b32 v11, 0
    v_mov_b32 v12, 0
    v_mov_b32 v13, 0
    s_mov_b32 s51, 16896
    s_mov_b32 s52, 15
    v_mfma_f32_32x32x16_bf16 a[96:111], v[156:159], v[156:159], 0
    v_mfma_f32_32x32x16_bf16 a[112:127], v[156:159], v[156:159], 0
    v_mfma_f32_32x32x16_bf16 a[128:143], v[156:159], v[156:159], 0
    v_mfma_f32_32x32x16_bf16 a[144:159], v[156:159], v[156:159], 0
    v_mov_b32 v5, v3
    v_mov_b32 v6, v4
    s_add_u32 m0, s59, 88832
    s_nop 0
    buffer_load_dwordx4 v15, s[16:19], s54 offen offset:0 nt lds
    s_add_u32 m0, s59, 88896
    s_nop 0
    buffer_load_dwordx4 v15, s[16:19], s54 offen offset:1024 nt lds
    s_add_u32 m0, s59, 88960
    s_nop 0
    buffer_load_dwordx4 v15, s[16:19], s54 offen offset:2048 nt lds
    s_add_u32 m0, s59, 89024
    s_nop 0
    buffer_load_dwordx4 v15, s[16:19], s54 offen offset:3072 nt lds
    s_waitcnt vmcnt(9)
    s_barrier
    ds_read_b128 v[136:139], v5 offset:0
    ds_read_b128 v[140:143], v5 offset:64
    ds_read_b128 v[144:147], v5 offset:128
    ds_read_b128 v[148:151], v5 offset:192
    ds_read_b128 a[160:163], v5 offset:512
    ds_read_b128 a[164:167], v5 offset:576
    ds_read_b128 a[168:171], v5 offset:640
    ds_read_b128 a[172:175], v5 offset:704
    ds_read_b128 a[224:227], v5 offset:8448
    ds_read_b128 a[228:231], v5 offset:8512
    ds_read_b128 a[232:235], v5 offset:8576
    ds_read_b128 a[236:239], v5 offset:8640
    ds_read_b128 a[240:243], v5 offset:8960
    ds_read_b128 a[244:247], v5 offset:9024
    ds_read_b128 a[248:251], v5 offset:9088
    ds_read_b128 a[252:255], v5 offset:9152
    ds_read_b64_tr_b16 a[192:193], v6 offset:0
    ds_read_b64_tr_b16 a[194:195], v6 offset:512
    ds_read_b64_tr_b16 a[196:197], v6 offset:32
    ds_read_b64_tr_b16 a[198:199], v6 offset:544
    ds_read_b64_tr_b16 a[200:201], v6 offset:64
    ds_read_b64_tr_b16 a[202:203], v6 offset:576
    ds_read_b64_tr_b16 a[204:205], v6 offset:96
    ds_read_b64_tr_b16 a[206:207], v6 offset:608
    ds_read_b64_tr_b16 a[208:209], v6 offset:128
    ds_read_b64_tr_b16 a[210:211], v6 offset:640
    ds_read_b64_tr_b16 a[212:213], v6 offset:160
    ds_read_b64_tr_b16 a[214:215], v6 offset:672
    ds_read_b64_tr_b16 a[216:217], v6 offset:192
    ds_read_b64_tr_b16 a[218:219], v6 offset:704
    ds_read_b64_tr_b16 a[220:221], v6 offset:224
    ds_read_b64_tr_b16 a[222:223], v6 offset:736
    v_add_u32 v5, 16896, v3
    s_waitcnt vmcnt(5)
    ds_read_b128 v[160:163], v152 offset:0
    ds_read_b128 v[164:167], v152 offset:64
    ds_read_b128 v[168:171], v152 offset:128
    ds_read_b128 v[172:175], v152 offset:192
    s_add_u32 m0, s59, 93184
    s_nop 0
    buffer_load_dwordx4 v15, s[16:19], s55 offen offset:0 nt lds
    s_add_u32 m0, s59, 93248
    s_nop 0
    buffer_load_dwordx4 v15, s[16:19], s55 offen offset:1024 nt lds
    s_add_u32 m0, s59, 93312
    s_nop 0
    buffer_load_dwordx4 v15, s[16:19], s55 offen offset:2048 nt lds
    s_add_u32 m0, s59, 93376
    s_nop 0
    buffer_load_dwordx4 v15, s[16:19], s55 offen offset:3072 nt lds
    s_waitcnt lgkmcnt(0)
    v_lshlrev_b32 v112, 16, v160
    v_and_b32 v113, s48, v160
    v_lshlrev_b32 v114, 16, v161
    v_and_b32 v115, s48, v161
    v_lshlrev_b32 v116, 16, v162
    v_and_b32 v117, s48, v162
    v_lshlrev_b32 v118, 16, v163
    v_and_b32 v119, s48, v163
    v_pk_mul_f32 v[112:113], v[112:113], s[40:41]
    v_pk_mul_f32 v[114:115], v[114:115], s[40:41]
    v_pk_mul_f32 v[116:117], v[116:117], s[40:41]
    v_pk_mul_f32 v[118:119], v[118:119], s[40:41]
    v_cvt_pk_bf16_f32 v160, v112, v113
    v_cvt_pk_bf16_f32 v161, v114, v115
    v_cvt_pk_bf16_f32 v162, v116, v117
    v_cvt_pk_bf16_f32 v163, v118, v119
    v_lshlrev_b32 v112, 16, v164
    v_and_b32 v113, s48, v164
    v_lshlrev_b32 v114, 16, v165
    v_and_b32 v115, s48, v165
    v_lshlrev_b32 v116, 16, v166
    v_and_b32 v117, s48, v166
    v_lshlrev_b32 v118, 16, v167
    v_and_b32 v119, s48, v167
    v_pk_mul_f32 v[112:113], v[112:113], s[40:41]
    v_pk_mul_f32 v[114:115], v[114:115], s[40:41]
    v_pk_mul_f32 v[116:117], v[116:117], s[40:41]
    v_pk_mul_f32 v[118:119], v[118:119], s[40:41]
    v_cvt_pk_bf16_f32 v164, v112, v113
    v_cvt_pk_bf16_f32 v165, v114, v115
    v_cvt_pk_bf16_f32 v166, v116, v117
    v_cvt_pk_bf16_f32 v167, v118, v119
    v_lshlrev_b32 v112, 16, v168
    v_and_b32 v113, s48, v168
    v_lshlrev_b32 v114, 16, v169
    v_and_b32 v115, s48, v169
    v_lshlrev_b32 v116, 16, v170
    v_and_b32 v117, s48, v170
    v_lshlrev_b32 v118, 16, v171
    v_and_b32 v119, s48, v171
    v_pk_mul_f32 v[112:113], v[112:113], s[40:41]
    v_pk_mul_f32 v[114:115], v[114:115], s[40:41]
    v_pk_mul_f32 v[116:117], v[116:117], s[40:41]
    v_pk_mul_f32 v[118:119], v[118:119], s[40:41]
    v_cvt_pk_bf16_f32 v168, v112, v113
    v_cvt_pk_bf16_f32 v169, v114, v115
    v_cvt_pk_bf16_f32 v170, v116, v117
    v_cvt_pk_bf16_f32 v171, v118, v119
    v_lshlrev_b32 v112, 16, v172
    v_and_b32 v113, s48, v172
    v_lshlrev_b32 v114, 16, v173
    v_and_b32 v115, s48, v173
    v_lshlrev_b32 v116, 16, v174
    v_and_b32 v117, s48, v174
    v_lshlrev_b32 v118, 16, v175
    v_and_b32 v119, s48, v175
    v_pk_mul_f32 v[112:113], v[112:113], s[40:41]
    v_pk_mul_f32 v[114:115], v[114:115], s[40:41]
    v_pk_mul_f32 v[116:117], v[116:117], s[40:41]
    v_pk_mul_f32 v[118:119], v[118:119], s[40:41]
    v_cvt_pk_bf16_f32 v172, v112, v113
    v_cvt_pk_bf16_f32 v173, v114, v115
    v_cvt_pk_bf16_f32 v174, v116, v117
    v_cvt_pk_bf16_f32 v175, v118, v119
    s_nop 1
    v_mfma_f32_16x16x32_bf16 v[112:115], v[136:139], v[160:163], 0
    v_mfma_f32_16x16x32_bf16 v[112:115], v[140:143], v[164:167], v[112:115]
    v_mfma_f32_16x16x32_bf16 v[112:115], v[144:147], v[168:171], v[112:115]
    v_mfma_f32_16x16x32_bf16 v[112:115], v[148:151], v[172:175], v[112:115]
    v_mfma_f32_16x16x32_bf16 v[116:119], a[160:163], v[160:163], 0
    v_mfma_f32_16x16x32_bf16 v[116:119], a[164:167], v[164:167], v[116:119]
    v_mfma_f32_16x16x32_bf16 v[116:119], a[168:171], v[168:171], v[116:119]
    v_mfma_f32_16x16x32_bf16 v[116:119], a[172:175], v[172:175], v[116:119]
    s_nop 7
    v_max_f32 v153, v112, v113
    v_max3_f32 v153, v153, v114, v115
    v_max3_f32 v153, v153, v116, v117
    v_max3_f32 v153, v153, v118, v119
    v_mov_b32 v154, v153
    s_nop 1
    v_permlane16_swap_b32 v153, v154
    v_max_f32 v153, v153, v154
    v_mov_b32 v154, v153
    s_nop 1
    v_permlane32_swap_b32 v153, v154
    v_max_f32 v153, v153, v154
    v_sub_f32 v16, 0, v153
    v_sub_f32 v17, 0, v153
    v_sub_f32 v18, 0, v153
    v_sub_f32 v19, 0, v153
    v_sub_f32 v112, v112, v153
    v_sub_f32 v113, v113, v153
    v_mfma_f32_16x16x32_bf16 v[40:43], a[224:227], v[160:163], v[16:19]
    v_sub_f32 v114, v114, v153
    v_sub_f32 v115, v115, v153
    v_mfma_f32_16x16x32_bf16 v[40:43], a[228:231], v[164:167], v[40:43]
    v_sub_f32 v116, v116, v153
    v_sub_f32 v117, v117, v153
    v_mfma_f32_16x16x32_bf16 v[40:43], a[232:235], v[168:171], v[40:43]
    v_sub_f32 v118, v118, v153
    v_sub_f32 v119, v119, v153
    v_mfma_f32_16x16x32_bf16 v[40:43], a[236:239], v[172:175], v[40:43]
    v_exp_f32 v112, v112
    v_mfma_f32_16x16x32_bf16 v[64:67], a[240:243], v[160:163], v[16:19]
    v_exp_f32 v113, v113
    v_mfma_f32_16x16x32_bf16 v[64:67], a[244:247], v[164:167], v[64:67]
    v_exp_f32 v114, v114
    v_mfma_f32_16x16x32_bf16 v[64:67], a[248:251], v[168:171], v[64:67]
    v_exp_f32 v115, v115
    v_mfma_f32_16x16x32_bf16 v[64:67], a[252:255], v[172:175], v[64:67]
    v_exp_f32 v116, v116
    v_exp_f32 v117, v117
    v_exp_f32 v118, v118
    v_exp_f32 v119, v119
    v_cvt_pk_bf16_f32 v88, v112, v113
    v_cvt_pk_bf16_f32 v89, v114, v115
    v_cvt_pk_bf16_f32 v90, v116, v117
    v_cvt_pk_bf16_f32 v91, v118, v119
    s_waitcnt vmcnt(4)
    ds_read_b128 v[176:179], v152 offset:4352
    ds_read_b128 v[180:183], v152 offset:4416
    ds_read_b128 v[184:187], v152 offset:4480
    ds_read_b128 v[188:191], v152 offset:4544
    s_add_u32 m0, s59, 97536
    v_add_f32 v8, v8, v112
    v_add_f32 v8, v8, v113
    v_mfma_f32_16x16x32_bf16 a[0:3], a[192:195], v[88:91], 0
    buffer_load_dwordx4 v15, s[16:19], s56 offen offset:0 nt lds
    s_add_u32 m0, s59, 97600
    v_exp_f32 v40, v40
    v_mfma_f32_16x16x32_bf16 a[4:7], a[196:199], v[88:91], 0
    buffer_load_dwordx4 v15, s[16:19], s56 offen offset:1024 nt lds
    s_add_u32 m0, s59, 97664
    v_exp_f32 v41, v41
    v_mfma_f32_16x16x32_bf16 a[8:11], a[200:203], v[88:91], 0
    buffer_load_dwordx4 v15, s[16:19], s56 offen offset:2048 nt lds
    s_add_u32 m0, s59, 97728
    v_exp_f32 v42, v42
    v_mfma_f32_16x16x32_bf16 a[12:15], a[204:207], v[88:91], 0
    buffer_load_dwordx4 v15, s[16:19], s56 offen offset:3072 nt lds
    v_exp_f32 v43, v43
    v_mfma_f32_16x16x32_bf16 a[16:19], a[208:211], v[88:91], 0
    v_add_f32 v8, v8, v114
    v_add_f32 v8, v8, v115
    v_mfma_f32_16x16x32_bf16 a[20:23], a[212:215], v[88:91], 0
    v_add_f32 v8, v8, v116
    v_add_f32 v8, v8, v117
    v_mfma_f32_16x16x32_bf16 a[24:27], a[216:219], v[88:91], 0
    v_add_f32 v8, v8, v118
    v_add_f32 v8, v8, v119
    v_mfma_f32_16x16x32_bf16 a[28:31], a[220:223], v[88:91], 0
    s_waitcnt lgkmcnt(0)
    v_lshlrev_b32 v112, 16, v176
    v_and_b32 v113, s48, v176
    v_lshlrev_b32 v114, 16, v177
    v_and_b32 v115, s48, v177
    v_lshlrev_b32 v116, 16, v178
    v_and_b32 v117, s48, v178
    v_lshlrev_b32 v118, 16, v179
    v_and_b32 v119, s48, v179
    v_pk_mul_f32 v[112:113], v[112:113], s[40:41]
    v_pk_mul_f32 v[114:115], v[114:115], s[40:41]
    v_pk_mul_f32 v[116:117], v[116:117], s[40:41]
    v_pk_mul_f32 v[118:119], v[118:119], s[40:41]
    v_cvt_pk_bf16_f32 v176, v112, v113
    v_cvt_pk_bf16_f32 v177, v114, v115
    v_cvt_pk_bf16_f32 v178, v116, v117
    v_cvt_pk_bf16_f32 v179, v118, v119
    v_lshlrev_b32 v112, 16, v180
    v_and_b32 v113, s48, v180
    v_lshlrev_b32 v114, 16, v181
    v_and_b32 v115, s48, v181
    v_lshlrev_b32 v116, 16, v182
    v_and_b32 v117, s48, v182
    v_lshlrev_b32 v118, 16, v183
    v_and_b32 v119, s48, v183
    v_pk_mul_f32 v[112:113], v[112:113], s[40:41]
    v_pk_mul_f32 v[114:115], v[114:115], s[40:41]
    v_pk_mul_f32 v[116:117], v[116:117], s[40:41]
    v_pk_mul_f32 v[118:119], v[118:119], s[40:41]
    v_cvt_pk_bf16_f32 v180, v112, v113
    v_cvt_pk_bf16_f32 v181, v114, v115
    v_cvt_pk_bf16_f32 v182, v116, v117
    v_cvt_pk_bf16_f32 v183, v118, v119
    v_lshlrev_b32 v112, 16, v184
    v_and_b32 v113, s48, v184
    v_lshlrev_b32 v114, 16, v185
    v_and_b32 v115, s48, v185
    v_lshlrev_b32 v116, 16, v186
    v_and_b32 v117, s48, v186
    v_lshlrev_b32 v118, 16, v187
    v_and_b32 v119, s48, v187
    v_pk_mul_f32 v[112:113], v[112:113], s[40:41]
    v_pk_mul_f32 v[114:115], v[114:115], s[40:41]
    v_pk_mul_f32 v[116:117], v[116:117], s[40:41]
    v_pk_mul_f32 v[118:119], v[118:119], s[40:41]
    v_cvt_pk_bf16_f32 v184, v112, v113
    v_cvt_pk_bf16_f32 v185, v114, v115
    v_cvt_pk_bf16_f32 v186, v116, v117
    v_cvt_pk_bf16_f32 v187, v118, v119
    v_lshlrev_b32 v112, 16, v188
    v_and_b32 v113, s48, v188
    v_lshlrev_b32 v114, 16, v189
    v_and_b32 v115, s48, v189
    v_lshlrev_b32 v116, 16, v190
    v_and_b32 v117, s48, v190
    v_lshlrev_b32 v118, 16, v191
    v_and_b32 v119, s48, v191
    v_pk_mul_f32 v[112:113], v[112:113], s[40:41]
    v_pk_mul_f32 v[114:115], v[114:115], s[40:41]
    v_pk_mul_f32 v[116:117], v[116:117], s[40:41]
    v_pk_mul_f32 v[118:119], v[118:119], s[40:41]
    v_cvt_pk_bf16_f32 v188, v112, v113
    v_cvt_pk_bf16_f32 v189, v114, v115
    v_cvt_pk_bf16_f32 v190, v116, v117
    v_cvt_pk_bf16_f32 v191, v118, v119
    s_nop 1
    v_mfma_f32_16x16x32_bf16 v[112:115], v[136:139], v[176:179], 0
    v_mfma_f32_16x16x32_bf16 v[112:115], v[140:143], v[180:183], v[112:115]
    v_mfma_f32_16x16x32_bf16 v[112:115], v[144:147], v[184:187], v[112:115]
    v_mfma_f32_16x16x32_bf16 v[112:115], v[148:151], v[188:191], v[112:115]
    v_mfma_f32_16x16x32_bf16 v[116:119], a[160:163], v[176:179], 0
    v_mfma_f32_16x16x32_bf16 v[116:119], a[164:167], v[180:183], v[116:119]
    v_mfma_f32_16x16x32_bf16 v[116:119], a[168:171], v[184:187], v[116:119]
    v_mfma_f32_16x16x32_bf16 v[116:119], a[172:175], v[188:191], v[116:119]
    v_add_f32 v8, v8, v40
    v_add_f32 v8, v8, v41
    v_add_f32 v8, v8, v42
    v_add_f32 v8, v8, v43
    s_nop 3
    v_max_f32 v153, v112, v113
    v_max3_f32 v153, v153, v114, v115
    v_max3_f32 v153, v153, v116, v117
    v_max3_f32 v153, v153, v118, v119
    v_mov_b32 v154, v153
    s_nop 1
    v_permlane16_swap_b32 v153, v154
    v_max_f32 v153, v153, v154
    v_mov_b32 v154, v153
    s_nop 1
    v_permlane32_swap_b32 v153, v154
    v_max_f32 v153, v153, v154
    v_sub_f32 v20, 0, v153
    v_sub_f32 v21, 0, v153
    v_sub_f32 v22, 0, v153
    v_sub_f32 v23, 0, v153
    v_sub_f32 v112, v112, v153
    v_sub_f32 v113, v113, v153
    v_mfma_f32_16x16x32_bf16 v[44:47], a[224:227], v[176:179], v[20:23]
    v_sub_f32 v114, v114, v153
    v_sub_f32 v115, v115, v153
    v_mfma_f32_16x16x32_bf16 v[44:47], a[228:231], v[180:183], v[44:47]
    v_sub_f32 v116, v116, v153
    v_sub_f32 v117, v117, v153
    v_mfma_f32_16x16x32_bf16 v[44:47], a[232:235], v[184:187], v[44:47]
    v_sub_f32 v118, v118, v153
    v_sub_f32 v119, v119, v153
    v_mfma_f32_16x16x32_bf16 v[44:47], a[236:239], v[188:191], v[44:47]
    v_exp_f32 v112, v112
    v_mfma_f32_16x16x32_bf16 v[68:71], a[240:243], v[176:179], v[20:23]
    v_exp_f32 v113, v113
    v_mfma_f32_16x16x32_bf16 v[68:71], a[244:247], v[180:183], v[68:71]
    v_exp_f32 v114, v114
    v_mfma_f32_16x16x32_bf16 v[68:71], a[248:251], v[184:187], v[68:71]
    v_exp_f32 v115, v115
    v_mfma_f32_16x16x32_bf16 v[68:71], a[252:255], v[188:191], v[68:71]
    v_exp_f32 v116, v116
    v_exp_f32 v117, v117
    v_exp_f32 v118, v118
    v_exp_f32 v119, v119
    v_cvt_pk_bf16_f32 v92, v112, v113
    v_cvt_pk_bf16_f32 v93, v114, v115
    v_cvt_pk_bf16_f32 v94, v116, v117
    v_cvt_pk_bf16_f32 v95, v118, v119
    s_waitcnt vmcnt(4)
    ds_read_b128 v[192:195], v152 offset:8704
    ds_read_b128 v[196:199], v152 offset:8768
    ds_read_b128 v[200:203], v152 offset:8832
    ds_read_b128 v[204:207], v152 offset:8896
    s_add_u32 m0, s59, 84480
    v_add_f32 v9, v9, v112
    v_add_f32 v9, v9, v113
    v_mfma_f32_16x16x32_bf16 a[32:35], a[192:195], v[92:95], 0
    buffer_load_dwordx4 v15, s[16:19], s57 offen offset:0 nt lds
    s_add_u32 m0, s59, 84544
    v_exp_f32 v44, v44
    v_mfma_f32_16x16x32_bf16 a[36:39], a[196:199], v[92:95], 0
    buffer_load_dwordx4 v15, s[16:19], s57 offen offset:1024 nt lds
    s_add_u32 m0, s59, 84608
    v_exp_f32 v45, v45
    v_mfma_f32_16x16x32_bf16 a[40:43], a[200:203], v[92:95], 0
    buffer_load_dwordx4 v15, s[16:19], s57 offen offset:2048 nt lds
    s_add_u32 m0, s59, 84672
    v_exp_f32 v46, v46
    v_mfma_f32_16x16x32_bf16 a[44:47], a[204:207], v[92:95], 0
    buffer_load_dwordx4 v15, s[16:19], s57 offen offset:3072 nt lds
    v_exp_f32 v47, v47
    v_mfma_f32_16x16x32_bf16 a[48:51], a[208:211], v[92:95], 0
    v_add_f32 v9, v9, v114
    v_add_f32 v9, v9, v115
    v_mfma_f32_16x16x32_bf16 a[52:55], a[212:215], v[92:95], 0
    v_add_f32 v9, v9, v116
    v_add_f32 v9, v9, v117
    v_mfma_f32_16x16x32_bf16 a[56:59], a[216:219], v[92:95], 0
    v_add_f32 v9, v9, v118
    v_add_f32 v9, v9, v119
    v_mfma_f32_16x16x32_bf16 a[60:63], a[220:223], v[92:95], 0
    s_waitcnt lgkmcnt(0)
    v_lshlrev_b32 v112, 16, v192
    v_and_b32 v113, s48, v192
    v_lshlrev_b32 v114, 16, v193
    v_and_b32 v115, s48, v193
    v_lshlrev_b32 v116, 16, v194
    v_and_b32 v117, s48, v194
    v_lshlrev_b32 v118, 16, v195
    v_and_b32 v119, s48, v195
    v_pk_mul_f32 v[112:113], v[112:113], s[40:41]
    v_pk_mul_f32 v[114:115], v[114:115], s[40:41]
    v_pk_mul_f32 v[116:117], v[116:117], s[40:41]
    v_pk_mul_f32 v[118:119], v[118:119], s[40:41]
    v_cvt_pk_bf16_f32 v192, v112, v113
    v_cvt_pk_bf16_f32 v193, v114, v115
    v_cvt_pk_bf16_f32 v194, v116, v117
    v_cvt_pk_bf16_f32 v195, v118, v119
    v_lshlrev_b32 v112, 16, v196
    v_and_b32 v113, s48, v196
    v_lshlrev_b32 v114, 16, v197
    v_and_b32 v115, s48, v197
    v_lshlrev_b32 v116, 16, v198
    v_and_b32 v117, s48, v198
    v_lshlrev_b32 v118, 16, v199
    v_and_b32 v119, s48, v199
    v_pk_mul_f32 v[112:113], v[112:113], s[40:41]
    v_pk_mul_f32 v[114:115], v[114:115], s[40:41]
    v_pk_mul_f32 v[116:117], v[116:117], s[40:41]
    v_pk_mul_f32 v[118:119], v[118:119], s[40:41]
    v_cvt_pk_bf16_f32 v196, v112, v113
    v_cvt_pk_bf16_f32 v197, v114, v115
    v_cvt_pk_bf16_f32 v198, v116, v117
    v_cvt_pk_bf16_f32 v199, v118, v119
    v_lshlrev_b32 v112, 16, v200
    v_and_b32 v113, s48, v200
    v_lshlrev_b32 v114, 16, v201
    v_and_b32 v115, s48, v201
    v_lshlrev_b32 v116, 16, v202
    v_and_b32 v117, s48, v202
    v_lshlrev_b32 v118, 16, v203
    v_and_b32 v119, s48, v203
    v_pk_mul_f32 v[112:113], v[112:113], s[40:41]
    v_pk_mul_f32 v[114:115], v[114:115], s[40:41]
    v_pk_mul_f32 v[116:117], v[116:117], s[40:41]
    v_pk_mul_f32 v[118:119], v[118:119], s[40:41]
    v_cvt_pk_bf16_f32 v200, v112, v113
    v_cvt_pk_bf16_f32 v201, v114, v115
    v_cvt_pk_bf16_f32 v202, v116, v117
    v_cvt_pk_bf16_f32 v203, v118, v119
    v_lshlrev_b32 v112, 16, v204
    v_and_b32 v113, s48, v204
    v_lshlrev_b32 v114, 16, v205
    v_and_b32 v115, s48, v205
    v_lshlrev_b32 v116, 16, v206
    v_and_b32 v117, s48, v206
    v_lshlrev_b32 v118, 16, v207
    v_and_b32 v119, s48, v207
    v_pk_mul_f32 v[112:113], v[112:113], s[40:41]
    v_pk_mul_f32 v[114:115], v[114:115], s[40:41]
    v_pk_mul_f32 v[116:117], v[116:117], s[40:41]
    v_pk_mul_f32 v[118:119], v[118:119], s[40:41]
    v_cvt_pk_bf16_f32 v204, v112, v113
    v_cvt_pk_bf16_f32 v205, v114, v115
    v_cvt_pk_bf16_f32 v206, v116, v117
    v_cvt_pk_bf16_f32 v207, v118, v119
    s_nop 1
    v_mfma_f32_16x16x32_bf16 v[112:115], v[136:139], v[192:195], 0
    v_mfma_f32_16x16x32_bf16 v[112:115], v[140:143], v[196:199], v[112:115]
    v_mfma_f32_16x16x32_bf16 v[112:115], v[144:147], v[200:203], v[112:115]
    v_mfma_f32_16x16x32_bf16 v[112:115], v[148:151], v[204:207], v[112:115]
    v_mfma_f32_16x16x32_bf16 v[116:119], a[160:163], v[192:195], 0
    v_mfma_f32_16x16x32_bf16 v[116:119], a[164:167], v[196:199], v[116:119]
    v_mfma_f32_16x16x32_bf16 v[116:119], a[168:171], v[200:203], v[116:119]
    v_mfma_f32_16x16x32_bf16 v[116:119], a[172:175], v[204:207], v[116:119]
    v_add_f32 v9, v9, v44
    v_add_f32 v9, v9, v45
    v_add_f32 v9, v9, v46
    v_add_f32 v9, v9, v47
    s_nop 3
    v_max_f32 v153, v112, v113
    v_max3_f32 v153, v153, v114, v115
    v_max3_f32 v153, v153, v116, v117
    v_max3_f32 v153, v153, v118, v119
    v_mov_b32 v154, v153
    s_nop 1
    v_permlane16_swap_b32 v153, v154
    v_max_f32 v153, v153, v154
    v_mov_b32 v154, v153
    s_nop 1
    v_permlane32_swap_b32 v153, v154
    v_max_f32 v153, v153, v154
    v_sub_f32 v24, 0, v153
    v_sub_f32 v25, 0, v153
    v_sub_f32 v26, 0, v153
    v_sub_f32 v27, 0, v153
    v_sub_f32 v112, v112, v153
    v_sub_f32 v113, v113, v153
    v_mfma_f32_16x16x32_bf16 v[48:51], a[224:227], v[192:195], v[24:27]
    v_sub_f32 v114, v114, v153
    v_sub_f32 v115, v115, v153
    v_mfma_f32_16x16x32_bf16 v[48:51], a[228:231], v[196:199], v[48:51]
    v_sub_f32 v116, v116, v153
    v_sub_f32 v117, v117, v153
    v_mfma_f32_16x16x32_bf16 v[48:51], a[232:235], v[200:203], v[48:51]
    v_sub_f32 v118, v118, v153
    v_sub_f32 v119, v119, v153
    v_mfma_f32_16x16x32_bf16 v[48:51], a[236:239], v[204:207], v[48:51]
    v_exp_f32 v112, v112
    v_mfma_f32_16x16x32_bf16 v[72:75], a[240:243], v[192:195], v[24:27]
    v_exp_f32 v113, v113
    v_mfma_f32_16x16x32_bf16 v[72:75], a[244:247], v[196:199], v[72:75]
    v_exp_f32 v114, v114
    v_mfma_f32_16x16x32_bf16 v[72:75], a[248:251], v[200:203], v[72:75]
    v_exp_f32 v115, v115
    v_mfma_f32_16x16x32_bf16 v[72:75], a[252:255], v[204:207], v[72:75]
    v_exp_f32 v116, v116
    v_exp_f32 v117, v117
    v_exp_f32 v118, v118
    v_exp_f32 v119, v119
    v_cvt_pk_bf16_f32 v96, v112, v113
    v_cvt_pk_bf16_f32 v97, v114, v115
    v_cvt_pk_bf16_f32 v98, v116, v117
    v_cvt_pk_bf16_f32 v99, v118, v119
    s_waitcnt vmcnt(4)
    ds_read_b128 v[208:211], v152 offset:13056
    ds_read_b128 v[212:215], v152 offset:13120
    ds_read_b128 v[216:219], v152 offset:13184
    ds_read_b128 v[220:223], v152 offset:13248
    s_add_u32 m0, s59, 88832
    v_add_f32 v10, v10, v112
    v_add_f32 v10, v10, v113
    v_mfma_f32_16x16x32_bf16 a[64:67], a[192:195], v[96:99], 0
    buffer_load_dwordx4 v15, s[16:19], s58 offen offset:0 nt lds
    s_add_u32 m0, s59, 88896
    v_exp_f32 v48, v48
    v_mfma_f32_16x16x32_bf16 a[68:71], a[196:199], v[96:99], 0
    buffer_load_dwordx4 v15, s[16:19], s58 offen offset:1024 nt lds
    s_add_u32 m0, s59, 88960
    v_exp_f32 v49, v49
    v_mfma_f32_16x16x32_bf16 a[72:75], a[200:203], v[96:99], 0
    buffer_load_dwordx4 v15, s[16:19], s58 offen offset:2048 nt lds
    s_add_u32 m0, s59, 89024
    v_exp_f32 v50, v50
    v_mfma_f32_16x16x32_bf16 a[76:79], a[204:207], v[96:99], 0
    buffer_load_dwordx4 v15, s[16:19], s58 offen offset:3072 nt lds
    v_exp_f32 v51, v51
    v_mfma_f32_16x16x32_bf16 a[80:83], a[208:211], v[96:99], 0
    v_add_f32 v10, v10, v114
    v_add_f32 v10, v10, v115
    v_mfma_f32_16x16x32_bf16 a[84:87], a[212:215], v[96:99], 0
    v_add_f32 v10, v10, v116
    v_add_f32 v10, v10, v117
    v_mfma_f32_16x16x32_bf16 a[88:91], a[216:219], v[96:99], 0
    v_add_f32 v10, v10, v118
    v_add_f32 v10, v10, v119
    v_mfma_f32_16x16x32_bf16 a[92:95], a[220:223], v[96:99], 0
    s_waitcnt lgkmcnt(0)
    v_lshlrev_b32 v112, 16, v208
    v_and_b32 v113, s48, v208
    v_lshlrev_b32 v114, 16, v209
    v_and_b32 v115, s48, v209
    v_lshlrev_b32 v116, 16, v210
    v_and_b32 v117, s48, v210
    v_lshlrev_b32 v118, 16, v211
    v_and_b32 v119, s48, v211
    v_pk_mul_f32 v[112:113], v[112:113], s[40:41]
    v_pk_mul_f32 v[114:115], v[114:115], s[40:41]
    v_pk_mul_f32 v[116:117], v[116:117], s[40:41]
    v_pk_mul_f32 v[118:119], v[118:119], s[40:41]
    v_cvt_pk_bf16_f32 v208, v112, v113
    v_cvt_pk_bf16_f32 v209, v114, v115
    v_cvt_pk_bf16_f32 v210, v116, v117
    v_cvt_pk_bf16_f32 v211, v118, v119
    v_lshlrev_b32 v112, 16, v212
    v_and_b32 v113, s48, v212
    v_lshlrev_b32 v114, 16, v213
    v_and_b32 v115, s48, v213
    v_lshlrev_b32 v116, 16, v214
    v_and_b32 v117, s48, v214
    v_lshlrev_b32 v118, 16, v215
    v_and_b32 v119, s48, v215
    v_pk_mul_f32 v[112:113], v[112:113], s[40:41]
    v_pk_mul_f32 v[114:115], v[114:115], s[40:41]
    v_pk_mul_f32 v[116:117], v[116:117], s[40:41]
    v_pk_mul_f32 v[118:119], v[118:119], s[40:41]
    v_cvt_pk_bf16_f32 v212, v112, v113
    v_cvt_pk_bf16_f32 v213, v114, v115
    v_cvt_pk_bf16_f32 v214, v116, v117
    v_cvt_pk_bf16_f32 v215, v118, v119
    v_lshlrev_b32 v112, 16, v216
    v_and_b32 v113, s48, v216
    v_lshlrev_b32 v114, 16, v217
    v_and_b32 v115, s48, v217
    v_lshlrev_b32 v116, 16, v218
    v_and_b32 v117, s48, v218
    v_lshlrev_b32 v118, 16, v219
    v_and_b32 v119, s48, v219
    v_pk_mul_f32 v[112:113], v[112:113], s[40:41]
    v_pk_mul_f32 v[114:115], v[114:115], s[40:41]
    v_pk_mul_f32 v[116:117], v[116:117], s[40:41]
    v_pk_mul_f32 v[118:119], v[118:119], s[40:41]
    v_cvt_pk_bf16_f32 v216, v112, v113
    v_cvt_pk_bf16_f32 v217, v114, v115
    v_cvt_pk_bf16_f32 v218, v116, v117
    v_cvt_pk_bf16_f32 v219, v118, v119
    v_lshlrev_b32 v112, 16, v220
    v_and_b32 v113, s48, v220
    v_lshlrev_b32 v114, 16, v221
    v_and_b32 v115, s48, v221
    v_lshlrev_b32 v116, 16, v222
    v_and_b32 v117, s48, v222
    v_lshlrev_b32 v118, 16, v223
    v_and_b32 v119, s48, v223
    v_pk_mul_f32 v[112:113], v[112:113], s[40:41]
    v_pk_mul_f32 v[114:115], v[114:115], s[40:41]
    v_pk_mul_f32 v[116:117], v[116:117], s[40:41]
    v_pk_mul_f32 v[118:119], v[118:119], s[40:41]
    v_cvt_pk_bf16_f32 v220, v112, v113
    v_cvt_pk_bf16_f32 v221, v114, v115
    v_cvt_pk_bf16_f32 v222, v116, v117
    v_cvt_pk_bf16_f32 v223, v118, v119
    s_nop 1
    v_mfma_f32_16x16x32_bf16 v[112:115], v[136:139], v[208:211], 0
    v_mfma_f32_16x16x32_bf16 v[112:115], v[140:143], v[212:215], v[112:115]
    v_mfma_f32_16x16x32_bf16 v[112:115], v[144:147], v[216:219], v[112:115]
    v_mfma_f32_16x16x32_bf16 v[112:115], v[148:151], v[220:223], v[112:115]
    v_mfma_f32_16x16x32_bf16 v[116:119], a[160:163], v[208:211], 0
    v_mfma_f32_16x16x32_bf16 v[116:119], a[164:167], v[212:215], v[116:119]
    v_mfma_f32_16x16x32_bf16 v[116:119], a[168:171], v[216:219], v[116:119]
    v_mfma_f32_16x16x32_bf16 v[116:119], a[172:175], v[220:223], v[116:119]
    v_add_f32 v10, v10, v48
    v_add_f32 v10, v10, v49
    v_add_f32 v10, v10, v50
    v_add_f32 v10, v10, v51
    s_nop 3
    v_max_f32 v153, v112, v113
    v_max3_f32 v153, v153, v114, v115
    v_max3_f32 v153, v153, v116, v117
    v_max3_f32 v153, v153, v118, v119
    v_mov_b32 v154, v153
    s_nop 1
    v_permlane16_swap_b32 v153, v154
    v_max_f32 v153, v153, v154
    v_mov_b32 v154, v153
    s_nop 1
    v_permlane32_swap_b32 v153, v154
    v_max_f32 v153, v153, v154
    v_sub_f32 v28, 0, v153
    v_sub_f32 v29, 0, v153
    v_sub_f32 v30, 0, v153
    v_sub_f32 v31, 0, v153
    v_sub_f32 v112, v112, v153
    v_sub_f32 v113, v113, v153
    v_mfma_f32_16x16x32_bf16 v[52:55], a[224:227], v[208:211], v[28:31]
    v_sub_f32 v114, v114, v153
    v_sub_f32 v115, v115, v153
    v_mfma_f32_16x16x32_bf16 v[52:55], a[228:231], v[212:215], v[52:55]
    v_sub_f32 v116, v116, v153
    v_sub_f32 v117, v117, v153
    v_mfma_f32_16x16x32_bf16 v[52:55], a[232:235], v[216:219], v[52:55]
    v_sub_f32 v118, v118, v153
    v_sub_f32 v119, v119, v153
    v_mfma_f32_16x16x32_bf16 v[52:55], a[236:239], v[220:223], v[52:55]
    v_exp_f32 v112, v112
    v_mfma_f32_16x16x32_bf16 v[76:79], a[240:243], v[208:211], v[28:31]
    v_exp_f32 v113, v113
    v_mfma_f32_16x16x32_bf16 v[76:79], a[244:247], v[212:215], v[76:79]
    v_exp_f32 v114, v114
    v_mfma_f32_16x16x32_bf16 v[76:79], a[248:251], v[216:219], v[76:79]
    v_exp_f32 v115, v115
    v_mfma_f32_16x16x32_bf16 v[76:79], a[252:255], v[220:223], v[76:79]
    v_exp_f32 v116, v116
    v_exp_f32 v117, v117
    v_exp_f32 v118, v118
    v_exp_f32 v119, v119
    v_cvt_pk_bf16_f32 v100, v112, v113
    v_cvt_pk_bf16_f32 v101, v114, v115
    v_cvt_pk_bf16_f32 v102, v116, v117
    v_cvt_pk_bf16_f32 v103, v118, v119
    s_waitcnt vmcnt(4)
    ds_read_b128 v[224:227], v152 offset:0
    ds_read_b128 v[228:231], v152 offset:64
    ds_read_b128 v[232:235], v152 offset:128
    ds_read_b128 v[236:239], v152 offset:192
    s_add_u32 s42, s3, 8192
    s_and_b32 s42, s42, 0x3ffff
    s_add_u32 m0, s37, 8448
    v_add_f32 v11, v11, v112
    v_add_f32 v11, v11, v113
    buffer_load_dwordx4 v2, s[24:27], s42 offen offset:0 nt lds
    s_add_u32 m0, s37, 9248
    v_add_f32 v11, v11, v114
    v_add_f32 v11, v11, v115
    buffer_load_dwordx4 v2, s[24:27], s42 offen offset:256 nt lds
    s_add_u32 s42, s3, 16384
    s_and_b32 s42, s42, 0x3ffff
    s_add_u32 m0, s36, 16896
    v_add_f32 v11, v11, v116
    v_add_f32 v11, v11, v117
    buffer_load_dwordx4 v2, s[20:23], s42 offen offset:0 nt lds
    s_add_u32 m0, s36, 17696
    v_add_f32 v11, v11, v118
    v_add_f32 v11, v11, v119
    buffer_load_dwordx4 v2, s[20:23], s42 offen offset:256 nt lds
    s_waitcnt lgkmcnt(0)
    v_lshlrev_b32 v112, 16, v224
    v_and_b32 v113, s48, v224
    v_lshlrev_b32 v114, 16, v225
    v_and_b32 v115, s48, v225
    v_lshlrev_b32 v116, 16, v226
    v_and_b32 v117, s48, v226
    v_lshlrev_b32 v118, 16, v227
    v_and_b32 v119, s48, v227
    v_pk_mul_f32 v[112:113], v[112:113], s[40:41]
    v_pk_mul_f32 v[114:115], v[114:115], s[40:41]
    v_pk_mul_f32 v[116:117], v[116:117], s[40:41]
    v_pk_mul_f32 v[118:119], v[118:119], s[40:41]
    v_cvt_pk_bf16_f32 v224, v112, v113
    v_cvt_pk_bf16_f32 v225, v114, v115
    v_cvt_pk_bf16_f32 v226, v116, v117
    v_cvt_pk_bf16_f32 v227, v118, v119
    v_lshlrev_b32 v112, 16, v228
    v_and_b32 v113, s48, v228
    v_lshlrev_b32 v114, 16, v229
    v_and_b32 v115, s48, v229
    v_lshlrev_b32 v116, 16, v230
    v_and_b32 v117, s48, v230
    v_lshlrev_b32 v118, 16, v231
    v_and_b32 v119, s48, v231
    v_pk_mul_f32 v[112:113], v[112:113], s[40:41]
    v_pk_mul_f32 v[114:115], v[114:115], s[40:41]
    v_pk_mul_f32 v[116:117], v[116:117], s[40:41]
    v_pk_mul_f32 v[118:119], v[118:119], s[40:41]
    v_cvt_pk_bf16_f32 v228, v112, v113
    v_cvt_pk_bf16_f32 v229, v114, v115
    v_cvt_pk_bf16_f32 v230, v116, v117
    v_cvt_pk_bf16_f32 v231, v118, v119
    v_lshlrev_b32 v112, 16, v232
    v_and_b32 v113, s48, v232
    v_lshlrev_b32 v114, 16, v233
    v_and_b32 v115, s48, v233
    v_lshlrev_b32 v116, 16, v234
    v_and_b32 v117, s48, v234
    v_lshlrev_b32 v118, 16, v235
    v_and_b32 v119, s48, v235
    v_pk_mul_f32 v[112:113], v[112:113], s[40:41]
    v_pk_mul_f32 v[114:115], v[114:115], s[40:41]
    v_pk_mul_f32 v[116:117], v[116:117], s[40:41]
    v_pk_mul_f32 v[118:119], v[118:119], s[40:41]
    v_cvt_pk_bf16_f32 v232, v112, v113
    v_cvt_pk_bf16_f32 v233, v114, v115
    v_cvt_pk_bf16_f32 v234, v116, v117
    v_cvt_pk_bf16_f32 v235, v118, v119
    v_lshlrev_b32 v112, 16, v236
    v_and_b32 v113, s48, v236
    v_lshlrev_b32 v114, 16, v237
    v_and_b32 v115, s48, v237
    v_lshlrev_b32 v116, 16, v238
    v_and_b32 v117, s48, v238
    v_lshlrev_b32 v118, 16, v239
    v_and_b32 v119, s48, v239
    v_pk_mul_f32 v[112:113], v[112:113], s[40:41]
    v_pk_mul_f32 v[114:115], v[114:115], s[40:41]
    v_pk_mul_f32 v[116:117], v[116:117], s[40:41]
    v_pk_mul_f32 v[118:119], v[118:119], s[40:41]
    v_cvt_pk_bf16_f32 v236, v112, v113
    v_cvt_pk_bf16_f32 v237, v114, v115
    v_cvt_pk_bf16_f32 v238, v116, v117
    v_cvt_pk_bf16_f32 v239, v118, v119
    s_nop 1
    v_mfma_f32_16x16x32_bf16 v[112:115], v[136:139], v[224:227], 0
    v_exp_f32 v52, v52
    v_mfma_f32_16x16x32_bf16 v[112:115], v[140:143], v[228:231], v[112:115]
    v_exp_f32 v53, v53
    v_mfma_f32_16x16x32_bf16 v[112:115], v[144:147], v[232:235], v[112:115]
    v_exp_f32 v54, v54
    v_mfma_f32_16x16x32_bf16 v[112:115], v[148:151], v[236:239], v[112:115]
    v_exp_f32 v55, v55
    v_mfma_f32_16x16x32_bf16 v[116:119], a[160:163], v[224:227], 0
    v_exp_f32 v76, v76
    v_mfma_f32_16x16x32_bf16 v[116:119], a[164:167], v[228:231], v[116:119]
    v_exp_f32 v77, v77
    v_mfma_f32_16x16x32_bf16 v[116:119], a[168:171], v[232:235], v[116:119]
    v_exp_f32 v78, v78
    v_mfma_f32_16x16x32_bf16 v[116:119], a[172:175], v[236:239], v[116:119]
    v_exp_f32 v79, v79
    v_cvt_pk_bf16_f32 v124, v52, v53
    v_cvt_pk_bf16_f32 v125, v54, v55
    v_cvt_pk_bf16_f32 v126, v76, v77
    v_cvt_pk_bf16_f32 v127, v78, v79
    v_add_f32 v11, v11, v52
    v_add_f32 v11, v11, v53
    v_add_f32 v11, v11, v54
    v_add_f32 v11, v11, v55
    v_add_f32 v11, v11, v76
    v_add_f32 v11, v11, v77
    v_add_f32 v11, v11, v78
    v_add_f32 v11, v11, v79
    v_max_f32 v153, v112, v113
    v_max3_f32 v153, v153, v114, v115
    v_max3_f32 v153, v153, v116, v117
    v_max3_f32 v153, v153, v118, v119
    v_mov_b32 v154, v153
    s_nop 1
    v_permlane16_swap_b32 v153, v154
    v_max_f32 v153, v153, v154
    v_mov_b32 v154, v153
    s_nop 1
    v_permlane32_swap_b32 v153, v154
    v_max_f32 v153, v153, v154
    v_sub_f32 v32, 0, v153
    v_sub_f32 v33, 0, v153
    v_sub_f32 v34, 0, v153
    v_sub_f32 v35, 0, v153
    v_sub_f32 v112, v112, v153
    v_sub_f32 v113, v113, v153
    v_mfma_f32_16x16x32_bf16 v[56:59], a[224:227], v[224:227], v[32:35]
    v_sub_f32 v114, v114, v153
    v_sub_f32 v115, v115, v153
    v_mfma_f32_16x16x32_bf16 v[56:59], a[228:231], v[228:231], v[56:59]
    v_sub_f32 v116, v116, v153
    v_sub_f32 v117, v117, v153
    v_mfma_f32_16x16x32_bf16 v[56:59], a[232:235], v[232:235], v[56:59]
    v_sub_f32 v118, v118, v153
    v_sub_f32 v119, v119, v153
    v_mfma_f32_16x16x32_bf16 v[56:59], a[236:239], v[236:239], v[56:59]
    v_exp_f32 v112, v112
    v_mfma_f32_16x16x32_bf16 v[80:83], a[240:243], v[224:227], v[32:35]
    v_exp_f32 v113, v113
    v_mfma_f32_16x16x32_bf16 v[80:83], a[244:247], v[228:231], v[80:83]
    v_exp_f32 v114, v114
    v_mfma_f32_16x16x32_bf16 v[80:83], a[248:251], v[232:235], v[80:83]
    v_exp_f32 v115, v115
    v_mfma_f32_16x16x32_bf16 v[80:83], a[252:255], v[236:239], v[80:83]
    v_exp_f32 v116, v116
    v_exp_f32 v117, v117
    v_exp_f32 v118, v118
    v_exp_f32 v119, v119
    v_cvt_pk_bf16_f32 v104, v112, v113
    v_cvt_pk_bf16_f32 v105, v114, v115
    v_cvt_pk_bf16_f32 v106, v116, v117
    v_cvt_pk_bf16_f32 v107, v118, v119
    s_cmp_eq_u32 s49, 3
    s_cbranch_scc1 L_lpre
    s_waitcnt vmcnt(4)
    ds_read_b128 v[240:243], v152 offset:4352
    ds_read_b128 v[244:247], v152 offset:4416
    ds_read_b128 v[248:251], v152 offset:4480
    ds_read_b128 v[252:255], v152 offset:4544
    v_add_f32 v12, v12, v112
    v_add_f32 v12, v12, v113
    v_add_f32 v12, v12, v114
    v_add_f32 v12, v12, v115
    v_add_f32 v12, v12, v116
    v_add_f32 v12, v12, v117
    v_add_f32 v12, v12, v118
    v_add_f32 v12, v12, v119
    s_waitcnt lgkmcnt(0)
    v_lshlrev_b32 v112, 16, v240
    v_and_b32 v113, s48, v240
    v_lshlrev_b32 v114, 16, v241
    v_and_b32 v115, s48, v241
    v_lshlrev_b32 v116, 16, v242
    v_and_b32 v117, s48, v242
    v_lshlrev_b32 v118, 16, v243
    v_and_b32 v119, s48, v243
    v_pk_mul_f32 v[112:113], v[112:113], s[40:41]
    v_pk_mul_f32 v[114:115], v[114:115], s[40:41]
    v_pk_mul_f32 v[116:117], v[116:117], s[40:41]
    v_pk_mul_f32 v[118:119], v[118:119], s[40:41]
    v_cvt_pk_bf16_f32 v240, v112, v113
    v_cvt_pk_bf16_f32 v241, v114, v115
    v_cvt_pk_bf16_f32 v242, v116, v117
    v_cvt_pk_bf16_f32 v243, v118, v119
    v_lshlrev_b32 v112, 16, v244
    v_and_b32 v113, s48, v244
    v_lshlrev_b32 v114, 16, v245
    v_and_b32 v115, s48, v245
    v_lshlrev_b32 v116, 16, v246
    v_and_b32 v117, s48, v246
    v_lshlrev_b32 v118, 16, v247
    v_and_b32 v119, s48, v247
    v_pk_mul_f32 v[112:113], v[112:113], s[40:41]
    v_pk_mul_f32 v[114:115], v[114:115], s[40:41]
    v_pk_mul_f32 v[116:117], v[116:117], s[40:41]
    v_pk_mul_f32 v[118:119], v[118:119], s[40:41]
    v_cvt_pk_bf16_f32 v244, v112, v113
    v_cvt_pk_bf16_f32 v245, v114, v115
    v_cvt_pk_bf16_f32 v246, v116, v117
    v_cvt_pk_bf16_f32 v247, v118, v119
    v_lshlrev_b32 v112, 16, v248
    v_and_b32 v113, s48, v248
    v_lshlrev_b32 v114, 16, v249
    v_and_b32 v115, s48, v249
    v_lshlrev_b32 v116, 16, v250
    v_and_b32 v117, s48, v250
    v_lshlrev_b32 v118, 16, v251
    v_and_b32 v119, s48, v251
    v_pk_mul_f32 v[112:113], v[112:113], s[40:41]
    v_pk_mul_f32 v[114:115], v[114:115], s[40:41]
    v_pk_mul_f32 v[116:117], v[116:117], s[40:41]
    v_pk_mul_f32 v[118:119], v[118:119], s[40:41]
    v_cvt_pk_bf16_f32 v248, v112, v113
    v_cvt_pk_bf16_f32 v249, v114, v115
    v_cvt_pk_bf16_f32 v250, v116, v117
    v_cvt_pk_bf16_f32 v251, v118, v119
    v_lshlrev_b32 v112, 16, v252
    v_and_b32 v113, s48, v252
    v_lshlrev_b32 v114, 16, v253
    v_and_b32 v115, s48, v253
    v_lshlrev_b32 v116, 16, v254
    v_and_b32 v117, s48, v254
    v_lshlrev_b32 v118, 16, v255
    v_and_b32 v119, s48, v255
    v_pk_mul_f32 v[112:113], v[112:113], s[40:41]
    v_pk_mul_f32 v[114:115], v[114:115], s[40:41]
    v_pk_mul_f32 v[116:117], v[116:117], s[40:41]
    v_pk_mul_f32 v[118:119], v[118:119], s[40:41]
    v_cvt_pk_bf16_f32 v252, v112, v113
    v_cvt_pk_bf16_f32 v253, v114, v115
    v_cvt_pk_bf16_f32 v254, v116, v117
    v_cvt_pk_bf16_f32 v255, v118, v119
    s_nop 1
    v_mfma_f32_16x16x32_bf16 v[112:115], v[136:139], v[240:243], 0
    v_exp_f32 v56, v56
    v_mfma_f32_16x16x32_bf16 v[112:115], v[140:143], v[244:247], v[112:115]
    v_exp_f32 v57, v57
    v_mfma_f32_16x16x32_bf16 v[112:115], v[144:147], v[248:251], v[112:115]
    v_exp_f32 v58, v58
    v_mfma_f32_16x16x32_bf16 v[112:115], v[148:151], v[252:255], v[112:115]
    v_exp_f32 v59, v59
    v_mfma_f32_16x16x32_bf16 v[116:119], a[160:163], v[240:243], 0
    v_exp_f32 v80, v80
    v_mfma_f32_16x16x32_bf16 v[116:119], a[164:167], v[244:247], v[116:119]
    v_exp_f32 v81, v81
    v_mfma_f32_16x16x32_bf16 v[116:119], a[168:171], v[248:251], v[116:119]
    v_exp_f32 v82, v82
    v_mfma_f32_16x16x32_bf16 v[116:119], a[172:175], v[252:255], v[116:119]
    v_mfma_f32_32x32x16_bf16 a[160:175], v[156:159], v[156:159], 0
    v_mfma_f32_32x32x16_bf16 a[176:191], v[156:159], v[156:159], 0
    v_exp_f32 v83, v83
    v_cvt_pk_bf16_f32 v128, v56, v57
    v_cvt_pk_bf16_f32 v129, v58, v59
    v_cvt_pk_bf16_f32 v130, v80, v81
    v_cvt_pk_bf16_f32 v131, v82, v83
    v_add_f32 v12, v12, v56
    v_add_f32 v12, v12, v57
    v_add_f32 v12, v12, v58
    v_add_f32 v12, v12, v59
    v_add_f32 v12, v12, v80
    v_add_f32 v12, v12, v81
    v_add_f32 v12, v12, v82
    v_add_f32 v12, v12, v83
    v_max_f32 v153, v112, v113
    v_max3_f32 v153, v153, v114, v115
    v_max3_f32 v153, v153, v116, v117
    v_max3_f32 v153, v153, v118, v119
    v_mov_b32 v154, v153
    s_nop 1
    v_permlane16_swap_b32 v153, v154
    v_max_f32 v153, v153, v154
    v_mov_b32 v154, v153
    s_nop 1
    v_permlane32_swap_b32 v153, v154
    v_max_f32 v153, v153, v154
    v_sub_f32 v36, 0, v153
    v_sub_f32 v37, 0, v153
    v_sub_f32 v38, 0, v153
    v_sub_f32 v39, 0, v153
    v_sub_f32 v112, v112, v153
    v_sub_f32 v113, v113, v153
    v_mfma_f32_16x16x32_bf16 v[60:63], a[224:227], v[240:243], v[36:39]
    v_sub_f32 v114, v114, v153
    v_sub_f32 v115, v115, v153
    v_mfma_f32_16x16x32_bf16 v[60:63], a[228:231], v[244:247], v[60:63]
    v_sub_f32 v116, v116, v153
    v_sub_f32 v117, v117, v153
    v_mfma_f32_16x16x32_bf16 v[60:63], a[232:235], v[248:251], v[60:63]
    v_sub_f32 v118, v118, v153
    v_sub_f32 v119, v119, v153
    v_mfma_f32_16x16x32_bf16 v[60:63], a[236:239], v[252:255], v[60:63]
    v_exp_f32 v112, v112
    v_mfma_f32_16x16x32_bf16 v[84:87], a[240:243], v[240:243], v[36:39]
    v_exp_f32 v113, v113
    v_mfma_f32_16x16x32_bf16 v[84:87], a[244:247], v[244:247], v[84:87]
    v_exp_f32 v114, v114
    v_mfma_f32_16x16x32_bf16 v[84:87], a[248:251], v[248:251], v[84:87]
    v_exp_f32 v115, v115
    v_mfma_f32_16x16x32_bf16 v[84:87], a[252:255], v[252:255], v[84:87]
    v_exp_f32 v116, v116
    v_exp_f32 v117, v117
    v_exp_f32 v118, v118
    v_exp_f32 v119, v119
    v_cvt_pk_bf16_f32 v108, v112, v113
    v_cvt_pk_bf16_f32 v109, v114, v115
    v_cvt_pk_bf16_f32 v110, v116, v117
    v_cvt_pk_bf16_f32 v111, v118, v119
    v_add_f32 v13, v13, v112
    v_add_f32 v13, v13, v113
    v_add_f32 v13, v13, v114
    v_add_f32 v13, v13, v115
    v_add_f32 v13, v13, v116
    v_add_f32 v13, v13, v117
    v_add_f32 v13, v13, v118
    v_add_f32 v13, v13, v119
    v_exp_f32 v60, v60
    v_exp_f32 v61, v61
    v_exp_f32 v62, v62
    v_exp_f32 v63, v63
    v_exp_f32 v84, v84
    v_exp_f32 v85, v85
    v_exp_f32 v86, v86
    v_exp_f32 v87, v87
    v_cvt_pk_bf16_f32 v132, v60, v61
    v_cvt_pk_bf16_f32 v133, v62, v63
    v_cvt_pk_bf16_f32 v134, v84, v85
    v_add_f32 v13, v13, v60
    v_add_f32 v13, v13, v61
    v_add_f32 v13, v13, v62
    v_add_f32 v13, v13, v63
    v_add_f32 v13, v13, v84
    v_add_f32 v13, v13, v85
    v_add_f32 v13, v13, v86
L_cstart:
    s_waitcnt vmcnt(0)
    s_barrier
    ds_read_b128 v[148:151], v5 offset:192
    ds_read_b128 v[144:147], v5 offset:128
    ds_read_b128 v[140:143], v5 offset:64
    ds_read_b128 v[136:139], v5 offset:0
    ds_read_b64_tr_b16 a[224:225], v6 offset:8448
    ds_read_b64_tr_b16 a[226:227], v6 offset:8960
    ds_read_b64_tr_b16 a[228:229], v6 offset:8480
    s_lshl_b32 s43, s49, 2
    s_add_u32 s43, s43, 154112
    v_mov_b32 v15, s43
    s_waitcnt lgkmcnt(3)
    v_mfma_f32_16x16x32_bf16 v[52:55], v[136:139], v[208:211], v[28:31]
    s_branch L_loop_mid
L_proend:
.p2align 12
.fill 320, 4, 0xbf800000
L_loop:
    v_exp_f32 v76, v76
    v_mfma_f32_16x16x32_bf16 v[40:43], v[140:143], v[164:167], v[40:43]
    v_cvt_pk_bf16_f32 v100, v52, v53
    v_cvt_pk_bf16_f32 v101, v54, v55
    v_mfma_f32_16x16x32_bf16 v[40:43], v[144:147], v[168:171], v[40:43]
    v_exp_f32 v77, v77
    v_mfma_f32_16x16x32_bf16 v[40:43], v[148:151], v[172:175], v[40:43]
    ds_read_b64_tr_b16 a[198:199], v6 offset:544
    v_cvt_pk_bf16_f32 v104, v56, v57
    v_mfma_f32_16x16x32_bf16 v[44:47], v[148:151], v[188:191], v[20:23]
    v_exp_f32 v78, v78
    v_mfma_f32_16x16x32_bf16 v[44:47], v[144:147], v[184:187], v[44:47]
    v_cvt_pk_bf16_f32 v105, v58, v59
    v_cvt_pk_bf16_f32 v108, v60, v61
    v_mfma_f32_16x16x32_bf16 v[44:47], v[140:143], v[180:183], v[44:47]
    v_exp_f32 v79, v79
    v_mfma_f32_16x16x32_bf16 v[44:47], v[136:139], v[176:179], v[44:47]
    ds_read_b64_tr_b16 a[200:201], v6 offset:64
    v_cvt_pk_bf16_f32 v109, v62, v63
    v_mfma_f32_16x16x32_bf16 v[48:51], v[136:139], v[192:195], v[24:27]
    v_exp_f32 v80, v80
    v_mfma_f32_16x16x32_bf16 v[48:51], v[140:143], v[196:199], v[48:51]
    v_cvt_pk_bf16_f32 v99, v74, v75
    v_cvt_pk_bf16_f32 v102, v76, v77
    v_mfma_f32_16x16x32_bf16 v[48:51], v[144:147], v[200:203], v[48:51]
    v_exp_f32 v81, v81
    v_mfma_f32_16x16x32_bf16 v[48:51], v[148:151], v[204:207], v[48:51]
    ds_read_b64_tr_b16 a[202:203], v6 offset:576
    v_cvt_pk_bf16_f32 v103, v78, v79
    v_mfma_f32_16x16x32_bf16 v[52:55], v[148:151], v[220:223], v[28:31]
    v_exp_f32 v82, v82
    v_mfma_f32_16x16x32_bf16 v[52:55], v[144:147], v[216:219], v[52:55]
    v_cvt_pk_bf16_f32 v106, v80, v81
    v_add_f32 v10, v10, v75
    v_mfma_f32_16x16x32_bf16 v[52:55], v[140:143], v[212:215], v[52:55]
    v_exp_f32 v83, v83
    v_mfma_f32_16x16x32_bf16 v[52:55], v[136:139], v[208:211], v[52:55]
    ds_read_b64_tr_b16 a[204:205], v6 offset:96
    v_add_f32 v11, v11, v76
    v_mfma_f32_16x16x32_bf16 v[56:59], v[136:139], v[224:227], v[32:35]
    v_exp_f32 v84, v84
    v_mfma_f32_16x16x32_bf16 v[56:59], v[140:143], v[228:231], v[56:59]
    v_cvt_pk_bf16_f32 v107, v82, v83
    v_add_f32 v11, v11, v77
    v_mfma_f32_16x16x32_bf16 v[56:59], v[144:147], v[232:235], v[56:59]
    v_exp_f32 v85, v85
    v_mfma_f32_16x16x32_bf16 v[56:59], v[148:151], v[236:239], v[56:59]
    ds_read_b64_tr_b16 a[206:207], v6 offset:608
    v_add_f32 v11, v11, v78
    v_mfma_f32_16x16x32_bf16 v[60:63], v[148:151], v[252:255], v[36:39]
    v_exp_f32 v86, v86
    v_mfma_f32_16x16x32_bf16 v[60:63], v[144:147], v[248:251], v[60:63]
    v_cvt_pk_bf16_f32 v110, v84, v85
    v_add_f32 v11, v11, v79
    v_mfma_f32_16x16x32_bf16 v[60:63], v[140:143], v[244:247], v[60:63]
    s_waitcnt lgkmcnt(6)
    v_exp_f32 v87, v87
    v_mfma_f32_16x16x32_bf16 v[60:63], v[136:139], v[240:243], v[60:63]
    ds_read_b128 v[148:151], v5 offset:9152
    v_add_f32 v12, v12, v80
    v_mfma_f32_16x16x32_bf16 a[0:3], a[224:227], v[112:115], a[0:3]
    v_exp_f32 v52, v52
    v_mfma_f32_16x16x32_bf16 a[0:3], a[192:195], v[88:91], a[0:3]
    v_cvt_pk_bf16_f32 v111, v86, v87
    v_add_f32 v12, v12, v81
    v_mfma_f32_16x16x32_bf16 a[32:35], a[192:195], v[92:95], a[32:35]
    v_exp_f32 v53, v53
    v_mfma_f32_16x16x32_bf16 a[32:35], a[224:227], v[116:119], a[32:35]
    ds_read_b128 v[144:147], v5 offset:9088
    v_add_f32 v12, v12, v82
    v_mfma_f32_16x16x32_bf16 a[64:67], a[224:227], v[120:123], a[64:67]
    v_exp_f32 v54, v54
    v_mfma_f32_16x16x32_bf16 a[64:67], a[192:195], v[96:99], a[64:67]
    s_waitcnt lgkmcnt(6)
    v_cvt_pk_bf16_f32 v124, v52, v53
    v_add_f32 v12, v12, v83
    v_mfma_f32_16x16x32_bf16 a[68:71], a[196:199], v[96:99], a[68:71]
    v_exp_f32 v55, v55
    v_mfma_f32_16x16x32_bf16 a[68:71], a[228:231], v[120:123], a[68:71]
    ds_read_b128 v[140:143], v5 offset:9024
    v_add_f32 v13, v13, v84
    v_mfma_f32_16x16x32_bf16 a[36:39], a[228:231], v[116:119], a[36:39]
    v_exp_f32 v56, v56
    v_mfma_f32_16x16x32_bf16 a[36:39], a[196:199], v[92:95], a[36:39]
    v_cvt_pk_bf16_f32 v125, v54, v55
    v_add_f32 v13, v13, v85
    v_mfma_f32_16x16x32_bf16 a[4:7], a[196:199], v[88:91], a[4:7]
    s_waitcnt lgkmcnt(5)
    v_exp_f32 v57, v57
    v_mfma_f32_16x16x32_bf16 a[4:7], a[228:231], v[112:115], a[4:7]
    ds_read_b128 v[136:139], v5 offset:8960
    v_add_f32 v13, v13, v86
    v_mfma_f32_16x16x32_bf16 a[8:11], a[232:235], v[112:115], a[8:11]
    v_exp_f32 v58, v58
    v_mfma_f32_16x16x32_bf16 a[8:11], a[200:203], v[88:91], a[8:11]
    v_cvt_pk_bf16_f32 v128, v56, v57
    v_add_f32 v13, v13, v87
    v_mfma_f32_16x16x32_bf16 a[40:43], a[200:203], v[92:95], a[40:43]
    v_exp_f32 v59, v59
    v_mfma_f32_16x16x32_bf16 a[40:43], a[232:235], v[116:119], a[40:43]
    ds_read_b64_tr_b16 a[208:209], v6 offset:128
    v_add_f32 v11, v11, v52
    v_mfma_f32_16x16x32_bf16 a[72:75], a[232:235], v[120:123], a[72:75]
    v_exp_f32 v60, v60
    v_mfma_f32_16x16x32_bf16 a[72:75], a[200:203], v[96:99], a[72:75]
    s_waitcnt lgkmcnt(5)
    v_cvt_pk_bf16_f32 v129, v58, v59
    v_add_f32 v11, v11, v53
    v_mfma_f32_16x16x32_bf16 a[76:79], a[204:207], v[96:99], a[76:79]
    v_exp_f32 v61, v61
    v_mfma_f32_16x16x32_bf16 a[76:79], a[236:239], v[120:123], a[76:79]
    ds_read_b64_tr_b16 a[210:211], v6 offset:640
    v_add_f32 v11, v11, v54
    v_mfma_f32_16x16x32_bf16 a[44:47], a[236:239], v[116:119], a[44:47]
    v_exp_f32 v62, v62
    v_mfma_f32_16x16x32_bf16 a[44:47], a[204:207], v[92:95], a[44:47]
    v_cvt_pk_bf16_f32 v132, v60, v61
    v_add_f32 v11, v11, v55
    v_mfma_f32_16x16x32_bf16 a[12:15], a[204:207], v[88:91], a[12:15]
    s_waitcnt lgkmcnt(2)
    v_exp_f32 v63, v63
    v_mfma_f32_16x16x32_bf16 a[12:15], a[236:239], v[112:115], a[12:15]
    ds_read_b64_tr_b16 a[212:213], v6 offset:160
    v_add_f32 v12, v12, v56
    v_mfma_f32_16x16x32_bf16 v[76:79], v[136:139], v[208:211], v[28:31]
    v_exp_f32 v40, v40
    v_mfma_f32_16x16x32_bf16 v[76:79], v[140:143], v[212:215], v[76:79]
    v_cvt_pk_bf16_f32 v133, v62, v63
    v_add_f32 v12, v12, v57
    v_mfma_f32_16x16x32_bf16 v[76:79], v[144:147], v[216:219], v[76:79]
    v_exp_f32 v41, v41
    v_mfma_f32_16x16x32_bf16 v[76:79], v[148:151], v[220:223], v[76:79]
    ds_read_b64_tr_b16 a[214:215], v6 offset:672
    v_add_f32 v12, v12, v58
    v_mfma_f32_16x16x32_bf16 v[80:83], v[148:151], v[236:239], v[32:35]
    v_exp_f32 v42, v42
    v_mfma_f32_16x16x32_bf16 v[80:83], v[144:147], v[232:235], v[80:83]
    v_add_f32 v12, v12, v59
    v_add_f32 v13, v13, v60
    v_mfma_f32_16x16x32_bf16 v[80:83], v[140:143], v[228:231], v[80:83]
    v_exp_f32 v43, v43
    v_mfma_f32_16x16x32_bf16 v[80:83], v[136:139], v[224:227], v[80:83]
    ds_read_b64_tr_b16 a[216:217], v6 offset:192
    v_add_f32 v13, v13, v61
    v_mfma_f32_16x16x32_bf16 v[84:87], v[136:139], v[240:243], v[36:39]
    v_exp_f32 v44, v44
    v_mfma_f32_16x16x32_bf16 v[84:87], v[140:143], v[244:247], v[84:87]
    v_add_f32 v13, v13, v62
    v_add_f32 v13, v13, v63
    v_mfma_f32_16x16x32_bf16 v[84:87], v[144:147], v[248:251], v[84:87]
    v_exp_f32 v45, v45
    v_mfma_f32_16x16x32_bf16 v[84:87], v[148:151], v[252:255], v[84:87]
    ds_read_b64_tr_b16 a[218:219], v6 offset:704
    v_add_f32 v8, v8, v40
    v_mfma_f32_16x16x32_bf16 v[64:67], v[148:151], v[172:175], v[16:19]
    v_exp_f32 v46, v46
    v_add_u32 v5, s51, v3
    v_mfma_f32_16x16x32_bf16 v[64:67], v[144:147], v[168:171], v[64:67]
    v_add_f32 v8, v8, v41
    v_add_f32 v8, v8, v42
    v_mfma_f32_16x16x32_bf16 v[64:67], v[140:143], v[164:167], v[64:67]
    v_exp_f32 v47, v47
    v_mfma_f32_16x16x32_bf16 v[64:67], v[136:139], v[160:163], v[64:67]
    ds_read_b64_tr_b16 a[220:221], v6 offset:224
    v_add_f32 v8, v8, v43
    v_mfma_f32_16x16x32_bf16 v[68:71], v[136:139], v[176:179], v[20:23]
    v_exp_f32 v48, v48
    v_mfma_f32_16x16x32_bf16 v[68:71], v[140:143], v[180:183], v[68:71]
    v_add_f32 v9, v9, v44
    v_add_f32 v9, v9, v45
    v_mfma_f32_16x16x32_bf16 v[68:71], v[144:147], v[184:187], v[68:71]
    v_exp_f32 v49, v49
    v_mfma_f32_16x16x32_bf16 v[68:71], v[148:151], v[188:191], v[68:71]
    ds_read_b64_tr_b16 a[222:223], v6 offset:736
    v_add_f32 v9, v9, v46
    v_mfma_f32_16x16x32_bf16 v[72:75], v[148:151], v[204:207], v[24:27]
    v_exp_f32 v50, v50
    v_mfma_f32_16x16x32_bf16 v[72:75], v[144:147], v[200:203], v[72:75]
    s_barrier
    v_add_f32 v9, v9, v47
    v_add_f32 v10, v10, v48
    v_mfma_f32_16x16x32_bf16 v[72:75], v[140:143], v[196:199], v[72:75]
    s_waitcnt lgkmcnt(6)
    v_exp_f32 v51, v51
    v_mfma_f32_16x16x32_bf16 v[72:75], v[136:139], v[192:195], v[72:75]
    ds_read_b128 v[148:151], v5 offset:192
    v_add_f32 v10, v10, v49
    v_mfma_f32_16x16x32_bf16 a[16:19], a[240:243], v[112:115], a[16:19]
    v_exp_f32 v76, v76
    v_mfma_f32_16x16x32_bf16 a[16:19], a[208:211], v[88:91], a[16:19]
    v_add_f32 v10, v10, v50
    v_add_f32 v10, v10, v51
    v_mfma_f32_16x16x32_bf16 a[48:51], a[208:211], v[92:95], a[48:51]
    v_exp_f32 v77, v77
    v_mfma_f32_16x16x32_bf16 a[48:51], a[240:243], v[116:119], a[48:51]
    ds_read_b128 v[144:147], v5 offset:128
    v_add_f32 v11, v11, v76
    v_mfma_f32_16x16x32_bf16 a[80:83], a[240:243], v[120:123], a[80:83]
    v_exp_f32 v78, v78
    v_mfma_f32_16x16x32_bf16 a[80:83], a[208:211], v[96:99], a[80:83]
    s_waitcnt lgkmcnt(6)
    v_cvt_pk_bf16_f32 v126, v76, v77
    v_add_f32 v11, v11, v77
    v_mfma_f32_16x16x32_bf16 a[84:87], a[212:215], v[96:99], a[84:87]
    v_exp_f32 v79, v79
    v_mfma_f32_16x16x32_bf16 a[84:87], a[244:247], v[120:123], a[84:87]
    ds_read_b128 v[140:143], v5 offset:64
    v_add_f32 v11, v11, v78
    v_mfma_f32_16x16x32_bf16 a[52:55], a[244:247], v[116:119], a[52:55]
    v_exp_f32 v80, v80
    v_mfma_f32_16x16x32_bf16 a[52:55], a[212:215], v[92:95], a[52:55]
    v_cvt_pk_bf16_f32 v127, v78, v79
    v_add_f32 v11, v11, v79
    v_mfma_f32_16x16x32_bf16 a[20:23], a[212:215], v[88:91], a[20:23]
    s_waitcnt lgkmcnt(5)
    v_exp_f32 v81, v81
    v_mfma_f32_16x16x32_bf16 a[20:23], a[244:247], v[112:115], a[20:23]
    ds_read_b128 v[136:139], v5 offset:0
    v_add_f32 v12, v12, v80
    v_mfma_f32_16x16x32_bf16 a[24:27], a[248:251], v[112:115], a[24:27]
    v_exp_f32 v82, v82
    v_mfma_f32_16x16x32_bf16 a[24:27], a[216:219], v[88:91], a[24:27]
    v_cvt_pk_bf16_f32 v130, v80, v81
    v_add_f32 v12, v12, v81
    v_mfma_f32_16x16x32_bf16 a[56:59], a[216:219], v[92:95], a[56:59]
    v_exp_f32 v83, v83
    v_mfma_f32_16x16x32_bf16 a[56:59], a[248:251], v[116:119], a[56:59]
    ds_read_b64_tr_b16 a[224:225], v6 offset:8448
    v_add_f32 v12, v12, v82
    v_mfma_f32_16x16x32_bf16 a[88:91], a[248:251], v[120:123], a[88:91]
    v_exp_f32 v84, v84
    v_mfma_f32_16x16x32_bf16 a[88:91], a[216:219], v[96:99], a[88:91]
    s_waitcnt lgkmcnt(5)
    v_cvt_pk_bf16_f32 v131, v82, v83
    v_add_f32 v12, v12, v83
    v_mfma_f32_16x16x32_bf16 a[92:95], a[220:223], v[96:99], a[92:95]
    v_exp_f32 v85, v85
    v_mfma_f32_16x16x32_bf16 a[92:95], a[252:255], v[120:123], a[92:95]
    ds_read_b64_tr_b16 a[226:227], v6 offset:8960
    v_add_f32 v13, v13, v84
    v_mfma_f32_16x16x32_bf16 a[60:63], a[252:255], v[116:119], a[60:63]
    v_exp_f32 v86, v86
    v_mfma_f32_16x16x32_bf16 a[60:63], a[220:223], v[92:95], a[60:63]
    v_cvt_pk_bf16_f32 v134, v84, v85
    v_add_f32 v13, v13, v85
    v_mfma_f32_16x16x32_bf16 a[28:31], a[220:223], v[88:91], a[28:31]
    s_waitcnt lgkmcnt(2)
    v_exp_f32 v87, v87
    v_mfma_f32_16x16x32_bf16 a[28:31], a[252:255], v[112:115], a[28:31]
    ds_read_b64_tr_b16 a[228:229], v6 offset:8480
    v_add_f32 v13, v13, v86
    v_mfma_f32_16x16x32_bf16 v[52:55], v[136:139], v[208:211], v[28:31]
L_loop_mid:
    v_exp_f32 v64, v64
    v_mfma_f32_16x16x32_bf16 v[52:55], v[140:143], v[212:215], v[52:55]
    v_cvt_pk_bf16_f32 v112, v40, v41
    v_cvt_pk_bf16_f32 v113, v42, v43
    v_mfma_f32_16x16x32_bf16 v[52:55], v[144:147], v[216:219], v[52:55]
    v_exp_f32 v65, v65
    v_mfma_f32_16x16x32_bf16 v[52:55], v[148:151], v[220:223], v[52:55]
    ds_read_b64_tr_b16 a[230:231], v6 offset:8992
    v_cvt_pk_bf16_f32 v116, v44, v45
    v_mfma_f32_16x16x32_bf16 v[56:59], v[148:151], v[236:239], v[32:35]
    v_exp_f32 v66, v66
    v_mfma_f32_16x16x32_bf16 v[56:59], v[144:147], v[232:235], v[56:59]
    v_cvt_pk_bf16_f32 v117, v46, v47
    v_cvt_pk_bf16_f32 v120, v48, v49
    v_mfma_f32_16x16x32_bf16 v[56:59], v[140:143], v[228:231], v[56:59]
    v_exp_f32 v67, v67
    v_mfma_f32_16x16x32_bf16 v[56:59], v[136:139], v[224:227], v[56:59]
    ds_read_b64_tr_b16 a[232:233], v6 offset:8512
    v_cvt_pk_bf16_f32 v121, v50, v51
    v_mfma_f32_16x16x32_bf16 v[60:63], v[136:139], v[240:243], v[36:39]
    v_exp_f32 v68, v68
    v_mfma_f32_16x16x32_bf16 v[60:63], v[140:143], v[244:247], v[60:63]
    v_cvt_pk_bf16_f32 v135, v86, v87
    v_cvt_pk_bf16_f32 v114, v64, v65
    v_mfma_f32_16x16x32_bf16 v[60:63], v[144:147], v[248:251], v[60:63]
    v_exp_f32 v69, v69
    v_mfma_f32_16x16x32_bf16 v[60:63], v[148:151], v[252:255], v[60:63]
    ds_read_b64_tr_b16 a[234:235], v6 offset:9024
    v_cvt_pk_bf16_f32 v115, v66, v67
    v_mfma_f32_16x16x32_bf16 v[40:43], v[148:151], v[172:175], v[16:19]
    v_exp_f32 v70, v70
    v_mfma_f32_16x16x32_bf16 v[40:43], v[144:147], v[168:171], v[40:43]
    v_cvt_pk_bf16_f32 v118, v68, v69
    v_add_f32 v13, v13, v87
    v_mfma_f32_16x16x32_bf16 v[40:43], v[140:143], v[164:167], v[40:43]
    v_exp_f32 v71, v71
    v_mfma_f32_16x16x32_bf16 v[40:43], v[136:139], v[160:163], v[40:43]
    ds_read_b64_tr_b16 a[236:237], v6 offset:8544
    v_add_f32 v8, v8, v64
    v_mfma_f32_16x16x32_bf16 v[44:47], v[136:139], v[176:179], v[20:23]
    v_exp_f32 v72, v72
    v_mfma_f32_16x16x32_bf16 v[44:47], v[140:143], v[180:183], v[44:47]
    v_cvt_pk_bf16_f32 v119, v70, v71
    v_add_f32 v8, v8, v65
    v_mfma_f32_16x16x32_bf16 v[44:47], v[144:147], v[184:187], v[44:47]
    v_exp_f32 v73, v73
    v_mfma_f32_16x16x32_bf16 v[44:47], v[148:151], v[188:191], v[44:47]
    ds_read_b64_tr_b16 a[238:239], v6 offset:9056
    v_add_f32 v8, v8, v66
    v_mfma_f32_16x16x32_bf16 v[48:51], v[148:151], v[204:207], v[24:27]
    v_exp_f32 v74, v74
    v_mfma_f32_16x16x32_bf16 v[48:51], v[144:147], v[200:203], v[48:51]
    v_cvt_pk_bf16_f32 v122, v72, v73
    v_add_f32 v8, v8, v67
    v_mfma_f32_16x16x32_bf16 v[48:51], v[140:143], v[196:199], v[48:51]
    s_waitcnt lgkmcnt(6)
    v_exp_f32 v75, v75
    v_mfma_f32_16x16x32_bf16 v[48:51], v[136:139], v[192:195], v[48:51]
    ds_read_b128 v[148:151], v5 offset:704
    v_add_f32 v9, v9, v68
    v_mfma_f32_16x16x32_bf16 a[96:99], a[192:195], v[100:103], a[96:99]
    v_exp_f32 v40, v40
    v_mfma_f32_16x16x32_bf16 a[96:99], a[224:227], v[124:127], a[96:99]
    v_cvt_pk_bf16_f32 v123, v74, v75
    v_add_f32 v9, v9, v69
    v_mfma_f32_16x16x32_bf16 a[128:131], a[224:227], v[128:131], a[128:131]
    v_exp_f32 v41, v41
    v_mfma_f32_16x16x32_bf16 a[128:131], a[192:195], v[104:107], a[128:131]
    ds_read_b128 v[144:147], v5 offset:640
    v_add_f32 v9, v9, v70
    v_mfma_f32_16x16x32_bf16 a[160:163], a[192:195], v[108:111], a[160:163]
    v_exp_f32 v42, v42
    v_mfma_f32_16x16x32_bf16 a[160:163], a[224:227], v[132:135], a[160:163]
    s_waitcnt lgkmcnt(6)
    v_add_f32 v9, v9, v71
    v_cvt_pk_bf16_f32 v88, v40, v41
    v_mfma_f32_16x16x32_bf16 a[164:167], a[228:231], v[132:135], a[164:167]
    v_exp_f32 v43, v43
    v_mfma_f32_16x16x32_bf16 a[164:167], a[196:199], v[108:111], a[164:167]
    ds_read_b128 v[140:143], v5 offset:576
    v_add_f32 v10, v10, v72
    v_mfma_f32_16x16x32_bf16 a[132:135], a[196:199], v[104:107], a[132:135]
    v_exp_f32 v44, v44
    v_mfma_f32_16x16x32_bf16 a[132:135], a[228:231], v[128:131], a[132:135]
    v_add_f32 v10, v10, v73
    v_cvt_pk_bf16_f32 v89, v42, v43
    v_mfma_f32_16x16x32_bf16 a[100:103], a[228:231], v[124:127], a[100:103]
    s_waitcnt lgkmcnt(5)
    v_exp_f32 v45, v45
    v_mfma_f32_16x16x32_bf16 a[100:103], a[196:199], v[100:103], a[100:103]
    ds_read_b128 v[136:139], v5 offset:512
    v_add_f32 v10, v10, v74
    v_mfma_f32_16x16x32_bf16 a[104:107], a[200:203], v[100:103], a[104:107]
    v_exp_f32 v46, v46
    v_mfma_f32_16x16x32_bf16 a[104:107], a[232:235], v[124:127], a[104:107]
    v_add_f32 v10, v10, v75
    v_cvt_pk_bf16_f32 v92, v44, v45
    v_mfma_f32_16x16x32_bf16 a[136:139], a[232:235], v[128:131], a[136:139]
    v_exp_f32 v47, v47
    v_mfma_f32_16x16x32_bf16 a[136:139], a[200:203], v[104:107], a[136:139]
    ds_read_b64_tr_b16 a[240:241], v6 offset:8576
    v_add_f32 v8, v8, v40
    v_mfma_f32_16x16x32_bf16 a[168:171], a[200:203], v[108:111], a[168:171]
    v_exp_f32 v48, v48
    v_mfma_f32_16x16x32_bf16 a[168:171], a[232:235], v[132:135], a[168:171]
    s_waitcnt lgkmcnt(5)
    v_cvt_pk_bf16_f32 v93, v46, v47
    v_add_f32 v8, v8, v41
    v_mfma_f32_16x16x32_bf16 a[172:175], a[236:239], v[132:135], a[172:175]
    v_exp_f32 v49, v49
    v_mfma_f32_16x16x32_bf16 a[172:175], a[204:207], v[108:111], a[172:175]
    ds_read_b64_tr_b16 a[242:243], v6 offset:9088
    v_add_f32 v8, v8, v42
    v_mfma_f32_16x16x32_bf16 a[140:143], a[204:207], v[104:107], a[140:143]
    v_exp_f32 v50, v50
    v_mfma_f32_16x16x32_bf16 a[140:143], a[236:239], v[128:131], a[140:143]
    v_cvt_pk_bf16_f32 v96, v48, v49
    v_add_f32 v8, v8, v43
    v_mfma_f32_16x16x32_bf16 a[108:111], a[236:239], v[124:127], a[108:111]
    s_waitcnt lgkmcnt(2)
    v_exp_f32 v51, v51
    v_mfma_f32_16x16x32_bf16 a[108:111], a[204:207], v[100:103], a[108:111]
    ds_read_b64_tr_b16 a[244:245], v6 offset:8608
    v_add_f32 v9, v9, v44
    v_mfma_f32_16x16x32_bf16 v[64:67], v[136:139], v[160:163], v[16:19]
    v_exp_f32 v52, v52
    v_mfma_f32_16x16x32_bf16 v[64:67], v[140:143], v[164:167], v[64:67]
    v_cvt_pk_bf16_f32 v97, v50, v51
    v_add_f32 v9, v9, v45
    v_mfma_f32_16x16x32_bf16 v[64:67], v[144:147], v[168:171], v[64:67]
    v_exp_f32 v53, v53
    v_mfma_f32_16x16x32_bf16 v[64:67], v[148:151], v[172:175], v[64:67]
    ds_read_b64_tr_b16 a[246:247], v6 offset:9120
    v_add_f32 v9, v9, v46
    v_mfma_f32_16x16x32_bf16 v[68:71], v[148:151], v[188:191], v[20:23]
    v_exp_f32 v54, v54
    v_mfma_f32_16x16x32_bf16 v[68:71], v[144:147], v[184:187], v[68:71]
    v_add_f32 v9, v9, v47
    v_add_f32 v10, v10, v48
    v_mfma_f32_16x16x32_bf16 v[68:71], v[140:143], v[180:183], v[68:71]
    v_exp_f32 v55, v55
    v_mfma_f32_16x16x32_bf16 v[68:71], v[136:139], v[176:179], v[68:71]
    ds_read_b64_tr_b16 a[248:249], v6 offset:8640
    v_add_f32 v10, v10, v49
    v_mfma_f32_16x16x32_bf16 v[72:75], v[136:139], v[192:195], v[24:27]
    v_exp_f32 v56, v56
    v_mfma_f32_16x16x32_bf16 v[72:75], v[140:143], v[196:199], v[72:75]
    v_add_f32 v10, v10, v50
    v_add_f32 v10, v10, v51
    v_mfma_f32_16x16x32_bf16 v[72:75], v[144:147], v[200:203], v[72:75]
    v_exp_f32 v57, v57
    v_mfma_f32_16x16x32_bf16 v[72:75], v[148:151], v[204:207], v[72:75]
    ds_read_b64_tr_b16 a[250:251], v6 offset:9152
    v_add_f32 v11, v11, v52
    v_mfma_f32_16x16x32_bf16 v[76:79], v[148:151], v[220:223], v[28:31]
    v_exp_f32 v58, v58
    v_mfma_f32_16x16x32_bf16 v[76:79], v[144:147], v[216:219], v[76:79]
    v_add_f32 v11, v11, v53
    v_add_f32 v11, v11, v54
    v_mfma_f32_16x16x32_bf16 v[76:79], v[140:143], v[212:215], v[76:79]
    v_exp_f32 v59, v59
    v_mfma_f32_16x16x32_bf16 v[76:79], v[136:139], v[208:211], v[76:79]
    ds_read_b64_tr_b16 a[252:253], v6 offset:8672
    v_add_f32 v11, v11, v55
    v_mfma_f32_16x16x32_bf16 v[80:83], v[136:139], v[224:227], v[32:35]
    v_exp_f32 v60, v60
    v_mfma_f32_16x16x32_bf16 v[80:83], v[140:143], v[228:231], v[80:83]
    v_add_f32 v12, v12, v56
    v_add_f32 v12, v12, v57
    v_mfma_f32_16x16x32_bf16 v[80:83], v[144:147], v[232:235], v[80:83]
    v_exp_f32 v61, v61
    v_mfma_f32_16x16x32_bf16 v[80:83], v[148:151], v[236:239], v[80:83]
    ds_read_b64_tr_b16 a[254:255], v6 offset:9184
    v_add_f32 v12, v12, v58
    v_mfma_f32_16x16x32_bf16 v[84:87], v[148:151], v[252:255], v[36:39]
    v_exp_f32 v62, v62
    v_add_u32 v6, s51, v4
    v_mfma_f32_16x16x32_bf16 v[84:87], v[144:147], v[248:251], v[84:87]
    s_barrier
    v_add_f32 v12, v12, v59
    v_add_f32 v13, v13, v60
    v_mfma_f32_16x16x32_bf16 v[84:87], v[140:143], v[244:247], v[84:87]
    s_waitcnt lgkmcnt(6)
    v_exp_f32 v63, v63
    v_mfma_f32_16x16x32_bf16 v[84:87], v[136:139], v[240:243], v[84:87]
    ds_read_b128 v[148:151], v5 offset:8640
    v_add_f32 v13, v13, v61
    v_mfma_f32_16x16x32_bf16 a[112:115], a[208:211], v[100:103], a[112:115]
    s_add_u32 s51, s51, 16896
    v_exp_f32 v64, v64
    v_mfma_f32_16x16x32_bf16 a[112:115], a[240:243], v[124:127], a[112:115]
    s_cmp_eq_u32 s51, 50688
    v_add_f32 v13, v13, v62
    v_add_f32 v13, v13, v63
    v_mfma_f32_16x16x32_bf16 a[144:147], a[240:243], v[128:131], a[144:147]
    s_cselect_b32 s51, 0, s51
    v_exp_f32 v65, v65
    v_mfma_f32_16x16x32_bf16 a[144:147], a[208:211], v[104:107], a[144:147]
    ds_read_b128 v[144:147], v5 offset:8576
    v_add_f32 v8, v8, v64
    v_mfma_f32_16x16x32_bf16 a[176:179], a[208:211], v[108:111], a[176:179]
    s_sub_u32 s52, s52, 1
    v_exp_f32 v66, v66
    v_mfma_f32_16x16x32_bf16 a[176:179], a[240:243], v[132:135], a[176:179]
    s_waitcnt lgkmcnt(6)
    v_cvt_pk_bf16_f32 v90, v64, v65
    v_add_f32 v8, v8, v65
    v_mfma_f32_16x16x32_bf16 a[180:183], a[244:247], v[132:135], a[180:183]
    s_cmp_lg_u32 s52, 0
    v_exp_f32 v67, v67
    v_mfma_f32_16x16x32_bf16 a[180:183], a[212:215], v[108:111], a[180:183]
    ds_read_b128 v[140:143], v5 offset:8512
    v_add_f32 v8, v8, v66
    v_mfma_f32_16x16x32_bf16 a[148:151], a[212:215], v[104:107], a[148:151]
    v_exp_f32 v68, v68
    v_mfma_f32_16x16x32_bf16 a[148:151], a[244:247], v[128:131], a[148:151]
    v_cvt_pk_bf16_f32 v91, v66, v67
    v_add_f32 v8, v8, v67
    v_mfma_f32_16x16x32_bf16 a[116:119], a[244:247], v[124:127], a[116:119]
    s_waitcnt lgkmcnt(5)
    v_exp_f32 v69, v69
    v_mfma_f32_16x16x32_bf16 a[116:119], a[212:215], v[100:103], a[116:119]
    ds_read_b128 v[136:139], v5 offset:8448
    v_add_f32 v9, v9, v68
    v_mfma_f32_16x16x32_bf16 a[120:123], a[216:219], v[100:103], a[120:123]
    v_exp_f32 v70, v70
    v_mfma_f32_16x16x32_bf16 a[120:123], a[248:251], v[124:127], a[120:123]
    v_cvt_pk_bf16_f32 v94, v68, v69
    v_add_f32 v9, v9, v69
    v_mfma_f32_16x16x32_bf16 a[152:155], a[248:251], v[128:131], a[152:155]
    v_exp_f32 v71, v71
    v_mfma_f32_16x16x32_bf16 a[152:155], a[216:219], v[104:107], a[152:155]
    ds_read_b64_tr_b16 a[192:193], v6 offset:0
    v_add_f32 v9, v9, v70
    v_mfma_f32_16x16x32_bf16 a[184:187], a[216:219], v[108:111], a[184:187]
    v_exp_f32 v72, v72
    v_mfma_f32_16x16x32_bf16 a[184:187], a[248:251], v[132:135], a[184:187]
    s_waitcnt lgkmcnt(5)
    v_cvt_pk_bf16_f32 v95, v70, v71
    v_add_f32 v9, v9, v71
    v_mfma_f32_16x16x32_bf16 a[188:191], a[252:255], v[132:135], a[188:191]
    v_exp_f32 v73, v73
    v_mfma_f32_16x16x32_bf16 a[188:191], a[220:223], v[108:111], a[188:191]
    ds_read_b64_tr_b16 a[194:195], v6 offset:512
    v_add_f32 v10, v10, v72
    v_mfma_f32_16x16x32_bf16 a[156:159], a[220:223], v[104:107], a[156:159]
    v_exp_f32 v74, v74
    v_mfma_f32_16x16x32_bf16 a[156:159], a[252:255], v[128:131], a[156:159]
    v_cvt_pk_bf16_f32 v98, v72, v73
    v_add_f32 v10, v10, v73
    v_mfma_f32_16x16x32_bf16 a[124:127], a[252:255], v[124:127], a[124:127]
    s_waitcnt lgkmcnt(2)
    v_exp_f32 v75, v75
    v_mfma_f32_16x16x32_bf16 a[124:127], a[220:223], v[100:103], a[124:127]
    ds_read_b64_tr_b16 a[196:197], v6 offset:32
    v_add_f32 v10, v10, v74
    v_mfma_f32_16x16x32_bf16 v[40:43], v[136:139], v[160:163], v[16:19]
    s_cbranch_scc1 L_loop
L_tail:
    ds_read_b128 v[124:127], v5 offset:8960
    v_mfma_f32_16x16x32_bf16 v[40:43], v[140:143], v[164:167], v[40:43]
    ds_read_b128 v[128:131], v5 offset:9024
    v_cvt_pk_bf16_f32 v100, v52, v53
    v_mfma_f32_16x16x32_bf16 v[40:43], v[144:147], v[168:171], v[40:43]
    ds_read_b128 v[132:135], v5 offset:9088
    v_cvt_pk_bf16_f32 v101, v54, v55
    v_mfma_f32_16x16x32_bf16 v[40:43], v[148:151], v[172:175], v[40:43]
    ds_read_b128 v[152:155], v5 offset:9152
    v_cvt_pk_bf16_f32 v104, v56, v57
    v_mfma_f32_16x16x32_bf16 a[0:3], a[224:227], v[112:115], a[0:3]
    ds_read_b64_tr_b16 a[198:199], v6 offset:544
    v_cvt_pk_bf16_f32 v105, v58, v59
    v_mfma_f32_16x16x32_bf16 a[32:35], a[224:227], v[116:119], a[32:35]
    ds_read_b64_tr_b16 a[200:201], v6 offset:64
    v_cvt_pk_bf16_f32 v108, v60, v61
    v_mfma_f32_16x16x32_bf16 a[64:67], a[224:227], v[120:123], a[64:67]
    ds_read_b64_tr_b16 a[202:203], v6 offset:576
    v_exp_f32 v40, v40
    v_mfma_f32_16x16x32_bf16 a[4:7], a[228:231], v[112:115], a[4:7]
    ds_read_b64_tr_b16 a[204:205], v6 offset:96
    v_exp_f32 v41, v41
    v_mfma_f32_16x16x32_bf16 a[36:39], a[228:231], v[116:119], a[36:39]
    ds_read_b64_tr_b16 a[206:207], v6 offset:608
    v_exp_f32 v42, v42
    v_mfma_f32_16x16x32_bf16 a[68:71], a[228:231], v[120:123], a[68:71]
    ds_read_b64_tr_b16 a[208:209], v6 offset:128
    v_add_f32 v8, v8, v40
    s_waitcnt lgkmcnt(6)
    v_mfma_f32_16x16x32_bf16 v[44:47], v[124:127], v[160:163], v[16:19]
    ds_read_b64_tr_b16 a[210:211], v6 offset:640
    v_exp_f32 v43, v43
    v_mfma_f32_16x16x32_bf16 v[44:47], v[128:131], v[164:167], v[44:47]
    ds_read_b64_tr_b16 a[212:213], v6 offset:160
    v_cvt_pk_bf16_f32 v156, v40, v41
    v_mfma_f32_16x16x32_bf16 v[44:47], v[132:135], v[168:171], v[44:47]
    ds_read_b64_tr_b16 a[214:215], v6 offset:672
    v_add_f32 v8, v8, v41
    v_mfma_f32_16x16x32_bf16 v[44:47], v[152:155], v[172:175], v[44:47]
    ds_read_b64_tr_b16 a[216:217], v6 offset:192
    v_cvt_pk_bf16_f32 v109, v62, v63
    v_mfma_f32_16x16x32_bf16 a[8:11], a[232:235], v[112:115], a[8:11]
    ds_read_b64_tr_b16 a[218:219], v6 offset:704
    v_cvt_pk_bf16_f32 v99, v74, v75
    v_mfma_f32_16x16x32_bf16 a[40:43], a[232:235], v[116:119], a[40:43]
    ds_read_b64_tr_b16 a[220:221], v6 offset:224
    v_add_f32 v10, v10, v75
    v_mfma_f32_16x16x32_bf16 a[72:75], a[232:235], v[120:123], a[72:75]
    ds_read_b64_tr_b16 a[222:223], v6 offset:736
    v_exp_f32 v44, v44
    v_mfma_f32_16x16x32_bf16 a[12:15], a[236:239], v[112:115], a[12:15]
    s_waitcnt vmcnt(24)
    v_add_f32 v8, v8, v42
    v_mfma_f32_16x16x32_bf16 a[44:47], a[236:239], v[116:119], a[44:47]
    s_barrier
    v_exp_f32 v45, v45
    v_mfma_f32_16x16x32_bf16 a[76:79], a[236:239], v[120:123], a[76:79]
    ds_read_b64_tr_b16 a[224:225], v6 offset:8448
    v_cvt_pk_bf16_f32 v157, v42, v43
    v_mfma_f32_16x16x32_bf16 a[16:19], a[240:243], v[112:115], a[16:19]
    ds_read_b64_tr_b16 a[226:227], v6 offset:8960
    v_add_f32 v8, v8, v43
    v_mfma_f32_16x16x32_bf16 a[48:51], a[240:243], v[116:119], a[48:51]
    ds_read_b64_tr_b16 a[228:229], v6 offset:8480
    v_exp_f32 v46, v46
    v_mfma_f32_16x16x32_bf16 a[80:83], a[240:243], v[120:123], a[80:83]
    ds_read_b64_tr_b16 a[230:231], v6 offset:8992
    v_add_f32 v8, v8, v44
    v_mfma_f32_16x16x32_bf16 a[20:23], a[244:247], v[112:115], a[20:23]
    ds_read_b64_tr_b16 a[232:233], v6 offset:8512
    v_exp_f32 v47, v47
    v_mfma_f32_16x16x32_bf16 a[52:55], a[244:247], v[116:119], a[52:55]
    ds_read_b64_tr_b16 a[234:235], v6 offset:9024
    v_cvt_pk_bf16_f32 v158, v44, v45
    v_mfma_f32_16x16x32_bf16 a[84:87], a[244:247], v[120:123], a[84:87]
    ds_read_b64_tr_b16 a[236:237], v6 offset:8544
    v_add_f32 v8, v8, v45
    v_mfma_f32_16x16x32_bf16 a[24:27], a[248:251], v[112:115], a[24:27]
    ds_read_b64_tr_b16 a[238:239], v6 offset:9056
    v_add_f32 v8, v8, v46
    v_mfma_f32_16x16x32_bf16 a[56:59], a[248:251], v[116:119], a[56:59]
    ds_read_b64_tr_b16 a[240:241], v6 offset:8576
    v_cvt_pk_bf16_f32 v159, v46, v47
    v_mfma_f32_16x16x32_bf16 a[88:91], a[248:251], v[120:123], a[88:91]
    ds_read_b64_tr_b16 a[242:243], v6 offset:9088
    ds_read_b64_tr_b16 a[244:245], v6 offset:8608
    v_add_f32 v8, v8, v47
    v_mfma_f32_16x16x32_bf16 a[28:31], a[252:255], v[112:115], a[28:31]
    ds_read_b64_tr_b16 a[246:247], v6 offset:9120
    ds_read_b64_tr_b16 a[248:249], v6 offset:8640
    v_mfma_f32_16x16x32_bf16 a[60:63], a[252:255], v[116:119], a[60:63]
    ds_read_b64_tr_b16 a[250:251], v6 offset:9152
    v_mfma_f32_16x16x32_bf16 a[92:95], a[252:255], v[120:123], a[92:95]
    ds_read_b64_tr_b16 a[252:253], v6 offset:8672
    ds_read_b64_tr_b16 a[254:255], v6 offset:9184
    v_mov_b32 v120, 1.0
    s_waitcnt lgkmcnt(8)
    v_mfma_f32_16x16x32_bf16 a[0:3], a[192:195], v[88:91], a[0:3]
    v_exp_f32 v76, v76
    v_mfma_f32_16x16x32_bf16 a[0:3], a[224:227], v[156:159], a[0:3]
    v_exp_f32 v77, v77
    v_mfma_f32_16x16x4_f32 v[116:119], v120, v8, 0
    v_exp_f32 v78, v78
    v_mfma_f32_16x16x32_bf16 a[4:7], a[196:199], v[88:91], a[4:7]
    v_exp_f32 v79, v79
    v_mfma_f32_16x16x32_bf16 a[4:7], a[228:231], v[156:159], a[4:7]
    v_cvt_pk_bf16_f32 v102, v76, v77
    v_mfma_f32_16x16x32_bf16 a[8:11], a[200:203], v[88:91], a[8:11]
    v_cvt_pk_bf16_f32 v103, v78, v79
    v_mfma_f32_16x16x32_bf16 a[8:11], a[232:235], v[156:159], a[8:11]
    v_add_f32 v11, v11, v76
    v_mfma_f32_16x16x32_bf16 a[12:15], a[204:207], v[88:91], a[12:15]
    v_add_f32 v11, v11, v77
    v_mfma_f32_16x16x32_bf16 a[12:15], a[236:239], v[156:159], a[12:15]
    v_add_f32 v11, v11, v78
    v_add_f32 v11, v11, v79
    s_waitcnt lgkmcnt(0)
    v_mfma_f32_16x16x32_bf16 a[16:19], a[208:211], v[88:91], a[16:19]
    v_accvgpr_read_b32 v160, a0
    v_accvgpr_read_b32 v161, a1
    v_mfma_f32_16x16x32_bf16 a[16:19], a[240:243], v[156:159], a[16:19]
    v_accvgpr_read_b32 v162, a2
    v_accvgpr_read_b32 v163, a3
    v_mfma_f32_16x16x32_bf16 a[20:23], a[212:215], v[88:91], a[20:23]
    v_accvgpr_read_b32 v164, a4
    v_accvgpr_read_b32 v165, a5
    v_mfma_f32_16x16x32_bf16 a[20:23], a[244:247], v[156:159], a[20:23]
    v_accvgpr_read_b32 v166, a6
    v_accvgpr_read_b32 v167, a7
    v_mfma_f32_16x16x32_bf16 a[24:27], a[216:219], v[88:91], a[24:27]
    v_accvgpr_read_b32 v168, a8
    v_accvgpr_read_b32 v169, a9
    v_mfma_f32_16x16x32_bf16 a[24:27], a[248:251], v[156:159], a[24:27]
    v_accvgpr_read_b32 v170, a10
    v_accvgpr_read_b32 v171, a11
    v_mfma_f32_16x16x32_bf16 a[28:31], a[220:223], v[88:91], a[28:31]
    v_accvgpr_read_b32 v172, a12
    v_accvgpr_read_b32 v173, a13
    v_mfma_f32_16x16x32_bf16 a[28:31], a[252:255], v[156:159], a[28:31]
    v_accvgpr_read_b32 v174, a14
    v_accvgpr_read_b32 v175, a15
    v_cmp_ngt_f32 vcc, 0x5d800000, v116
    v_rcp_f32 v8, v116
    s_mov_b64 s[44:45], vcc
    v_accvgpr_read_b32 v56, a16
    v_accvgpr_read_b32 v57, a17
    v_accvgpr_read_b32 v58, a18
    v_pk_mul_f32 v[160:161], v[160:161], v[8:9] op_sel_hi:[1,0]
    v_pk_mul_f32 v[162:163], v[162:163], v[8:9] op_sel_hi:[1,0]
    v_pk_mul_f32 v[164:165], v[164:165], v[8:9] op_sel_hi:[1,0]
    v_pk_mul_f32 v[166:167], v[166:167], v[8:9] op_sel_hi:[1,0]
    v_pk_mul_f32 v[168:169], v[168:169], v[8:9] op_sel_hi:[1,0]
    v_pk_mul_f32 v[170:171], v[170:171], v[8:9] op_sel_hi:[1,0]
    v_pk_mul_f32 v[172:173], v[172:173], v[8:9] op_sel_hi:[1,0]
    v_pk_mul_f32 v[174:175], v[174:175], v[8:9] op_sel_hi:[1,0]
    v_cvt_pk_bf16_f32 v160, v160, v161
    v_cvt_pk_bf16_f32 v161, v162, v163
    v_mfma_f32_16x16x32_bf16 v[48:51], v[136:139], v[176:179], v[20:23]
    ds_write_b64 v1, v[160:161] offset:0
    v_cvt_pk_bf16_f32 v162, v164, v165
    v_cvt_pk_bf16_f32 v163, v166, v167
    v_mfma_f32_16x16x32_bf16 v[48:51], v[140:143], v[180:183], v[48:51]
    ds_write_b64 v1, v[162:163] offset:32
    v_cvt_pk_bf16_f32 v164, v168, v169
    v_cvt_pk_bf16_f32 v165, v170, v171
    v_mfma_f32_16x16x32_bf16 v[48:51], v[144:147], v[184:187], v[48:51]
    ds_write_b64 v1, v[164:165] offset:64
    v_cvt_pk_bf16_f32 v166, v172, v173
    v_cvt_pk_bf16_f32 v167, v174, v175
    v_mfma_f32_16x16x32_bf16 v[48:51], v[148:151], v[188:191], v[48:51]
    ds_write_b64 v1, v[166:167] offset:96
    v_mfma_f32_16x16x32_bf16 v[52:55], v[124:127], v[176:179], v[20:23]
    ds_read_b128 v[168:171], v0 offset:0
    v_mfma_f32_16x16x32_bf16 v[52:55], v[128:131], v[180:183], v[52:55]
    ds_read_b128 v[172:175], v0 offset:2176
    v_accvgpr_read_b32 v59, a19
    v_mfma_f32_16x16x32_bf16 v[52:55], v[132:135], v[184:187], v[52:55]
    v_accvgpr_read_b32 v60, a20
    v_accvgpr_read_b32 v61, a21
    v_accvgpr_read_b32 v62, a22
    v_accvgpr_read_b32 v63, a23
    v_mfma_f32_16x16x32_bf16 v[52:55], v[152:155], v[188:191], v[52:55]
    v_accvgpr_read_b32 v64, a24
    v_accvgpr_read_b32 v65, a25
    v_accvgpr_read_b32 v66, a26
    v_accvgpr_read_b32 v67, a27
    v_accvgpr_read_b32 v68, a28
    v_accvgpr_read_b32 v69, a29
    v_accvgpr_read_b32 v70, a30
    v_accvgpr_read_b32 v71, a31
    v_pk_mul_f32 v[56:57], v[56:57], v[8:9] op_sel_hi:[1,0]
    v_pk_mul_f32 v[58:59], v[58:59], v[8:9] op_sel_hi:[1,0]
    v_pk_mul_f32 v[60:61], v[60:61], v[8:9] op_sel_hi:[1,0]
    v_pk_mul_f32 v[62:63], v[62:63], v[8:9] op_sel_hi:[1,0]
    v_pk_mul_f32 v[64:65], v[64:65], v[8:9] op_sel_hi:[1,0]
    v_pk_mul_f32 v[66:67], v[66:67], v[8:9] op_sel_hi:[1,0]
    v_pk_mul_f32 v[68:69], v[68:69], v[8:9] op_sel_hi:[1,0]
    v_pk_mul_f32 v[70:71], v[70:71], v[8:9] op_sel_hi:[1,0]
    s_waitcnt lgkmcnt(0)
    v_mfma_f32_16x16x32_bf16 a[32:35], a[192:195], v[92:95], a[32:35]
    buffer_store_dwordx4 v[168:171], v7, s[28:31], s53 offen offset:0 nt
    v_cvt_pk_bf16_f32 v56, v56, v57
    v_cvt_pk_bf16_f32 v57, v58, v59
    v_mfma_f32_16x16x32_bf16 a[36:39], a[196:199], v[92:95], a[36:39]
    ds_write_b64 v1, v[56:57] offset:128
    v_cvt_pk_bf16_f32 v58, v60, v61
    v_cvt_pk_bf16_f32 v59, v62, v63
    v_mfma_f32_16x16x32_bf16 a[40:43], a[200:203], v[92:95], a[40:43]
    ds_write_b64 v1, v[58:59] offset:160
    v_cvt_pk_bf16_f32 v60, v64, v65
    v_cvt_pk_bf16_f32 v61, v66, v67
    v_mfma_f32_16x16x32_bf16 a[44:47], a[204:207], v[92:95], a[44:47]
    ds_write_b64 v1, v[60:61] offset:192
    v_cvt_pk_bf16_f32 v62, v68, v69
    v_cvt_pk_bf16_f32 v63, v70, v71
    v_mfma_f32_16x16x32_bf16 a[48:51], a[208:211], v[92:95], a[48:51]
    ds_write_b64 v1, v[62:63] offset:224
    v_mfma_f32_16x16x32_bf16 a[52:55], a[212:215], v[92:95], a[52:55]
    ds_read_b128 v[64:67], v0 offset:128
    v_mfma_f32_16x16x32_bf16 a[56:59], a[216:219], v[92:95], a[56:59]
    ds_read_b128 v[68:71], v0 offset:2304
    v_mfma_f32_16x16x32_bf16 a[60:63], a[220:223], v[92:95], a[60:63]
    buffer_store_dwordx4 v[172:175], v7, s[28:31], s53 offen offset:2048 nt
    v_exp_f32 v48, v48
    v_exp_f32 v49, v49
    v_exp_f32 v50, v50
    v_exp_f32 v51, v51
    v_cvt_pk_bf16_f32 v112, v48, v49
    v_exp_f32 v52, v52
    v_exp_f32 v53, v53
    v_cvt_pk_bf16_f32 v113, v50, v51
    v_exp_f32 v54, v54
    v_exp_f32 v55, v55
    v_cvt_pk_bf16_f32 v114, v52, v53
    v_add_f32 v9, v9, v48
    v_cvt_pk_bf16_f32 v115, v54, v55
    s_waitcnt lgkmcnt(0)
    v_add_f32 v9, v9, v49
    v_mfma_f32_16x16x32_bf16 a[32:35], a[224:227], v[112:115], a[32:35]
    buffer_store_dwordx4 v[64:67], v7, s[28:31], s53 offen offset:128 nt
    v_mfma_f32_16x16x32_bf16 a[36:39], a[228:231], v[112:115], a[36:39]
    v_add_f32 v9, v9, v50
    v_add_f32 v9, v9, v51
    v_mfma_f32_16x16x32_bf16 a[40:43], a[232:235], v[112:115], a[40:43]
    v_add_f32 v9, v9, v52
    v_add_f32 v9, v9, v53
    v_mfma_f32_16x16x32_bf16 a[44:47], a[236:239], v[112:115], a[44:47]
    v_add_f32 v9, v9, v54
    v_add_f32 v9, v9, v55
    v_mfma_f32_16x16x32_bf16 a[48:51], a[240:243], v[112:115], a[48:51]
    v_accvgpr_read_b32 v176, a32
    v_accvgpr_read_b32 v177, a33
    v_mfma_f32_16x16x4_f32 v[116:119], v120, v9, 0
    buffer_store_dwordx4 v[68:71], v7, s[28:31], s53 offen offset:2176 nt
    v_accvgpr_read_b32 v178, a34
    v_accvgpr_read_b32 v179, a35
    v_accvgpr_read_b32 v180, a36
    v_accvgpr_read_b32 v181, a37
    v_mfma_f32_16x16x32_bf16 a[52:55], a[244:247], v[112:115], a[52:55]
    v_accvgpr_read_b32 v182, a38
    v_accvgpr_read_b32 v183, a39
    v_mfma_f32_16x16x32_bf16 a[56:59], a[248:251], v[112:115], a[56:59]
    v_accvgpr_read_b32 v184, a40
    v_accvgpr_read_b32 v185, a41
    v_mfma_f32_16x16x32_bf16 a[60:63], a[252:255], v[112:115], a[60:63]
    v_accvgpr_read_b32 v186, a42
    v_accvgpr_read_b32 v187, a43
    v_accvgpr_read_b32 v188, a44
    v_accvgpr_read_b32 v189, a45
    v_cmp_ngt_f32 vcc, 0x5d800000, v116
    v_rcp_f32 v9, v116
    s_or_b64 s[44:45], s[44:45], vcc
    v_accvgpr_read_b32 v190, a46
    v_accvgpr_read_b32 v191, a47
    v_pk_mul_f32 v[176:177], v[176:177], v[8:9] op_sel:[0,1] op_sel_hi:[1,1]
    v_pk_mul_f32 v[178:179], v[178:179], v[8:9] op_sel:[0,1] op_sel_hi:[1,1]
    v_pk_mul_f32 v[180:181], v[180:181], v[8:9] op_sel:[0,1] op_sel_hi:[1,1]
    v_pk_mul_f32 v[182:183], v[182:183], v[8:9] op_sel:[0,1] op_sel_hi:[1,1]
    v_pk_mul_f32 v[184:185], v[184:185], v[8:9] op_sel:[0,1] op_sel_hi:[1,1]
    v_pk_mul_f32 v[186:187], v[186:187], v[8:9] op_sel:[0,1] op_sel_hi:[1,1]
    v_pk_mul_f32 v[188:189], v[188:189], v[8:9] op_sel:[0,1] op_sel_hi:[1,1]
    v_pk_mul_f32 v[190:191], v[190:191], v[8:9] op_sel:[0,1] op_sel_hi:[1,1]
    v_cvt_pk_bf16_f32 v176, v176, v177
    v_cvt_pk_bf16_f32 v177, v178, v179
    v_mfma_f32_16x16x32_bf16 v[40:43], v[136:139], v[192:195], v[24:27]
    ds_write_b64 v1, v[176:177] offset:4352
    v_cvt_pk_bf16_f32 v178, v180, v181
    v_cvt_pk_bf16_f32 v179, v182, v183
    v_mfma_f32_16x16x32_bf16 v[40:43], v[140:143], v[196:199], v[40:43]
    ds_write_b64 v1, v[178:179] offset:4384
    v_cvt_pk_bf16_f32 v180, v184, v185
    v_cvt_pk_bf16_f32 v181, v186, v187
    v_mfma_f32_16x16x32_bf16 v[40:43], v[144:147], v[200:203], v[40:43]
    ds_write_b64 v1, v[180:181] offset:4416
    v_cvt_pk_bf16_f32 v182, v188, v189
    v_cvt_pk_bf16_f32 v183, v190, v191
    v_mfma_f32_16x16x32_bf16 v[40:43], v[148:151], v[204:207], v[40:43]
    ds_write_b64 v1, v[182:183] offset:4448
    v_mfma_f32_16x16x32_bf16 v[44:47], v[124:127], v[192:195], v[24:27]
    ds_read_b128 v[184:187], v0 offset:4352
    v_mfma_f32_16x16x32_bf16 v[44:47], v[128:131], v[196:199], v[44:47]
    ds_read_b128 v[188:191], v0 offset:6528
    v_accvgpr_read_b32 v56, a48
    v_mfma_f32_16x16x32_bf16 v[44:47], v[132:135], v[200:203], v[44:47]
    v_accvgpr_read_b32 v57, a49
    v_accvgpr_read_b32 v58, a50
    v_accvgpr_read_b32 v59, a51
    v_accvgpr_read_b32 v60, a52
    v_mfma_f32_16x16x32_bf16 v[44:47], v[152:155], v[204:207], v[44:47]
    v_accvgpr_read_b32 v61, a53
    v_accvgpr_read_b32 v62, a54
    v_accvgpr_read_b32 v63, a55
    v_accvgpr_read_b32 v64, a56
    v_mfma_f32_16x16x32_bf16 a[64:67], a[192:195], v[96:99], a[64:67]
    v_accvgpr_read_b32 v65, a57
    v_accvgpr_read_b32 v66, a58
    v_accvgpr_read_b32 v67, a59
    v_accvgpr_read_b32 v68, a60
    v_accvgpr_read_b32 v69, a61
    v_accvgpr_read_b32 v70, a62
    v_accvgpr_read_b32 v71, a63
    v_pk_mul_f32 v[56:57], v[56:57], v[8:9] op_sel:[0,1] op_sel_hi:[1,1]
    v_pk_mul_f32 v[58:59], v[58:59], v[8:9] op_sel:[0,1] op_sel_hi:[1,1]
    v_pk_mul_f32 v[60:61], v[60:61], v[8:9] op_sel:[0,1] op_sel_hi:[1,1]
    v_pk_mul_f32 v[62:63], v[62:63], v[8:9] op_sel:[0,1] op_sel_hi:[1,1]
    v_pk_mul_f32 v[64:65], v[64:65], v[8:9] op_sel:[0,1] op_sel_hi:[1,1]
    v_pk_mul_f32 v[66:67], v[66:67], v[8:9] op_sel:[0,1] op_sel_hi:[1,1]
    v_pk_mul_f32 v[68:69], v[68:69], v[8:9] op_sel:[0,1] op_sel_hi:[1,1]
    v_pk_mul_f32 v[70:71], v[70:71], v[8:9] op_sel:[0,1] op_sel_hi:[1,1]
    s_waitcnt lgkmcnt(0)
    v_mfma_f32_16x16x32_bf16 a[68:71], a[196:199], v[96:99], a[68:71]
    buffer_store_dwordx4 v[184:187], v7, s[28:31], s54 offen offset:0 nt
    v_cvt_pk_bf16_f32 v56, v56, v57
    v_cvt_pk_bf16_f32 v57, v58, v59
    v_mfma_f32_16x16x32_bf16 a[72:75], a[200:203], v[96:99], a[72:75]
    ds_write_b64 v1, v[56:57] offset:4480
    v_cvt_pk_bf16_f32 v58, v60, v61
    v_cvt_pk_bf16_f32 v59, v62, v63
    v_mfma_f32_16x16x32_bf16 a[76:79], a[204:207], v[96:99], a[76:79]
    ds_write_b64 v1, v[58:59] offset:4512
    v_cvt_pk_bf16_f32 v60, v64, v65
    v_cvt_pk_bf16_f32 v61, v66, v67
    v_mfma_f32_16x16x32_bf16 a[80:83], a[208:211], v[96:99], a[80:83]
    ds_write_b64 v1, v[60:61] offset:4544
    v_cvt_pk_bf16_f32 v62, v68, v69
    v_cvt_pk_bf16_f32 v63, v70, v71
    v_mfma_f32_16x16x32_bf16 a[84:87], a[212:215], v[96:99], a[84:87]
    ds_write_b64 v1, v[62:63] offset:4576
    v_mfma_f32_16x16x32_bf16 a[88:91], a[216:219], v[96:99], a[88:91]
    ds_read_b128 v[64:67], v0 offset:4480
    v_mfma_f32_16x16x32_bf16 a[92:95], a[220:223], v[96:99], a[92:95]
    ds_read_b128 v[68:71], v0 offset:6656
    buffer_store_dwordx4 v[188:191], v7, s[28:31], s54 offen offset:2048 nt
    v_exp_f32 v40, v40
    v_exp_f32 v41, v41
    v_exp_f32 v42, v42
    v_exp_f32 v43, v43
    v_cvt_pk_bf16_f32 v156, v40, v41
    v_exp_f32 v44, v44
    v_exp_f32 v45, v45
    v_cvt_pk_bf16_f32 v157, v42, v43
    v_exp_f32 v46, v46
    v_exp_f32 v47, v47
    v_cvt_pk_bf16_f32 v158, v44, v45
    v_add_f32 v10, v10, v40
    v_cvt_pk_bf16_f32 v159, v46, v47
    s_waitcnt lgkmcnt(0)
    v_add_f32 v10, v10, v41
    v_mfma_f32_16x16x32_bf16 a[64:67], a[224:227], v[156:159], a[64:67]
    buffer_store_dwordx4 v[64:67], v7, s[28:31], s54 offen offset:128 nt
    v_mfma_f32_16x16x32_bf16 a[68:71], a[228:231], v[156:159], a[68:71]
    v_add_f32 v10, v10, v42
    v_add_f32 v10, v10, v43
    v_mfma_f32_16x16x32_bf16 a[72:75], a[232:235], v[156:159], a[72:75]
    v_add_f32 v10, v10, v44
    v_add_f32 v10, v10, v45
    v_mfma_f32_16x16x32_bf16 a[76:79], a[236:239], v[156:159], a[76:79]
    v_add_f32 v10, v10, v46
    v_add_f32 v10, v10, v47
    v_mfma_f32_16x16x32_bf16 a[80:83], a[240:243], v[156:159], a[80:83]
    v_accvgpr_read_b32 v192, a64
    v_accvgpr_read_b32 v193, a65
    v_mfma_f32_16x16x4_f32 v[116:119], v120, v10, 0
    buffer_store_dwordx4 v[68:71], v7, s[28:31], s54 offen offset:2176 nt
    v_accvgpr_read_b32 v194, a66
    v_accvgpr_read_b32 v195, a67
    v_accvgpr_read_b32 v196, a68
    v_accvgpr_read_b32 v197, a69
    v_mfma_f32_16x16x32_bf16 a[84:87], a[244:247], v[156:159], a[84:87]
    v_accvgpr_read_b32 v198, a70
    v_accvgpr_read_b32 v199, a71
    v_mfma_f32_16x16x32_bf16 a[88:91], a[248:251], v[156:159], a[88:91]
    v_accvgpr_read_b32 v200, a72
    v_accvgpr_read_b32 v201, a73
    v_mfma_f32_16x16x32_bf16 a[92:95], a[252:255], v[156:159], a[92:95]
    v_accvgpr_read_b32 v202, a74
    v_accvgpr_read_b32 v203, a75
    v_accvgpr_read_b32 v204, a76
    v_accvgpr_read_b32 v205, a77
    v_cmp_ngt_f32 vcc, 0x5d800000, v116
    v_rcp_f32 v10, v116
    s_or_b64 s[44:45], s[44:45], vcc
    v_accvgpr_read_b32 v206, a78
    v_accvgpr_read_b32 v207, a79
    v_pk_mul_f32 v[192:193], v[192:193], v[10:11] op_sel_hi:[1,0]
    v_pk_mul_f32 v[194:195], v[194:195], v[10:11] op_sel_hi:[1,0]
    v_pk_mul_f32 v[196:197], v[196:197], v[10:11] op_sel_hi:[1,0]
    v_pk_mul_f32 v[198:199], v[198:199], v[10:11] op_sel_hi:[1,0]
    v_pk_mul_f32 v[200:201], v[200:201], v[10:11] op_sel_hi:[1,0]
    v_pk_mul_f32 v[202:203], v[202:203], v[10:11] op_sel_hi:[1,0]
    v_pk_mul_f32 v[204:205], v[204:205], v[10:11] op_sel_hi:[1,0]
    v_pk_mul_f32 v[206:207], v[206:207], v[10:11] op_sel_hi:[1,0]
    v_cvt_pk_bf16_f32 v192, v192, v193
    v_cvt_pk_bf16_f32 v193, v194, v195
    v_mfma_f32_16x16x32_bf16 v[48:51], v[136:139], v[208:211], v[28:31]
    ds_write_b64 v1, v[192:193] offset:8704
    v_cvt_pk_bf16_f32 v194, v196, v197
    v_cvt_pk_bf16_f32 v195, v198, v199
    v_mfma_f32_16x16x32_bf16 v[48:51], v[140:143], v[212:215], v[48:51]
    ds_write_b64 v1, v[194:195] offset:8736
    v_cvt_pk_bf16_f32 v196, v200, v201
    v_cvt_pk_bf16_f32 v197, v202, v203
    v_mfma_f32_16x16x32_bf16 v[48:51], v[144:147], v[216:219], v[48:51]
    ds_write_b64 v1, v[196:197] offset:8768
    v_cvt_pk_bf16_f32 v198, v204, v205
    v_cvt_pk_bf16_f32 v199, v206, v207
    v_mfma_f32_16x16x32_bf16 v[48:51], v[148:151], v[220:223], v[48:51]
    ds_write_b64 v1, v[198:199] offset:8800
    v_mfma_f32_16x16x32_bf16 v[52:55], v[124:127], v[208:211], v[28:31]
    ds_read_b128 v[200:203], v0 offset:8704
    v_mfma_f32_16x16x32_bf16 v[52:55], v[128:131], v[212:215], v[52:55]
    ds_read_b128 v[204:207], v0 offset:10880
    v_accvgpr_read_b32 v56, a80
    v_mfma_f32_16x16x32_bf16 v[52:55], v[132:135], v[216:219], v[52:55]
    v_accvgpr_read_b32 v57, a81
    v_accvgpr_read_b32 v58, a82
    v_accvgpr_read_b32 v59, a83
    v_accvgpr_read_b32 v60, a84
    v_mfma_f32_16x16x32_bf16 v[52:55], v[152:155], v[220:223], v[52:55]
    v_accvgpr_read_b32 v61, a85
    v_accvgpr_read_b32 v62, a86
    v_accvgpr_read_b32 v63, a87
    v_accvgpr_read_b32 v64, a88
    v_mfma_f32_16x16x32_bf16 a[96:99], a[192:195], v[100:103], a[96:99]
    v_accvgpr_read_b32 v65, a89
    v_accvgpr_read_b32 v66, a90
    v_accvgpr_read_b32 v67, a91
    v_accvgpr_read_b32 v68, a92
    v_accvgpr_read_b32 v69, a93
    v_accvgpr_read_b32 v70, a94
    v_accvgpr_read_b32 v71, a95
    v_pk_mul_f32 v[56:57], v[56:57], v[10:11] op_sel_hi:[1,0]
    v_pk_mul_f32 v[58:59], v[58:59], v[10:11] op_sel_hi:[1,0]
    v_pk_mul_f32 v[60:61], v[60:61], v[10:11] op_sel_hi:[1,0]
    v_pk_mul_f32 v[62:63], v[62:63], v[10:11] op_sel_hi:[1,0]
    v_pk_mul_f32 v[64:65], v[64:65], v[10:11] op_sel_hi:[1,0]
    v_pk_mul_f32 v[66:67], v[66:67], v[10:11] op_sel_hi:[1,0]
    v_pk_mul_f32 v[68:69], v[68:69], v[10:11] op_sel_hi:[1,0]
    v_pk_mul_f32 v[70:71], v[70:71], v[10:11] op_sel_hi:[1,0]
    s_waitcnt lgkmcnt(0)
    v_mfma_f32_16x16x32_bf16 a[100:103], a[196:199], v[100:103], a[100:103]
    buffer_store_dwordx4 v[200:203], v7, s[28:31], s55 offen offset:0 nt
    v_cvt_pk_bf16_f32 v56, v56, v57
    v_cvt_pk_bf16_f32 v57, v58, v59
    v_mfma_f32_16x16x32_bf16 a[104:107], a[200:203], v[100:103], a[104:107]
    ds_write_b64 v1, v[56:57] offset:8832
    v_cvt_pk_bf16_f32 v58, v60, v61
    v_cvt_pk_bf16_f32 v59, v62, v63
    v_mfma_f32_16x16x32_bf16 a[108:111], a[204:207], v[100:103], a[108:111]
    ds_write_b64 v1, v[58:59] offset:8864
    v_cvt_pk_bf16_f32 v60, v64, v65
    v_cvt_pk_bf16_f32 v61, v66, v67
    v_mfma_f32_16x16x32_bf16 a[112:115], a[208:211], v[100:103], a[112:115]
    ds_write_b64 v1, v[60:61] offset:8896
    v_cvt_pk_bf16_f32 v62, v68, v69
    v_cvt_pk_bf16_f32 v63, v70, v71
    v_mfma_f32_16x16x32_bf16 a[116:119], a[212:215], v[100:103], a[116:119]
    ds_write_b64 v1, v[62:63] offset:8928
    v_mfma_f32_16x16x32_bf16 a[120:123], a[216:219], v[100:103], a[120:123]
    ds_read_b128 v[64:67], v0 offset:8832
    v_mfma_f32_16x16x32_bf16 a[124:127], a[220:223], v[100:103], a[124:127]
    ds_read_b128 v[68:71], v0 offset:11008
    buffer_store_dwordx4 v[204:207], v7, s[28:31], s55 offen offset:2048 nt
    v_exp_f32 v80, v80
    v_exp_f32 v81, v81
    v_exp_f32 v82, v82
    v_exp_f32 v83, v83
    v_cvt_pk_bf16_f32 v106, v80, v81
    v_cvt_pk_bf16_f32 v107, v82, v83
    v_add_f32 v12, v12, v80
    v_add_f32 v12, v12, v81
    v_add_f32 v12, v12, v82
    v_add_f32 v12, v12, v83
    v_exp_f32 v48, v48
    v_exp_f32 v49, v49
    v_exp_f32 v50, v50
    v_exp_f32 v51, v51
    v_cvt_pk_bf16_f32 v112, v48, v49
    v_exp_f32 v52, v52
    v_exp_f32 v53, v53
    v_cvt_pk_bf16_f32 v113, v50, v51
    v_exp_f32 v54, v54
    v_exp_f32 v55, v55
    v_cvt_pk_bf16_f32 v114, v52, v53
    v_add_f32 v11, v11, v48
    v_cvt_pk_bf16_f32 v115, v54, v55
    s_waitcnt lgkmcnt(0)
    v_add_f32 v11, v11, v49
    v_mfma_f32_16x16x32_bf16 a[96:99], a[224:227], v[112:115], a[96:99]
    buffer_store_dwordx4 v[64:67], v7, s[28:31], s55 offen offset:128 nt
    v_mfma_f32_16x16x32_bf16 a[100:103], a[228:231], v[112:115], a[100:103]
    v_add_f32 v11, v11, v50
    v_add_f32 v11, v11, v51
    v_mfma_f32_16x16x32_bf16 a[104:107], a[232:235], v[112:115], a[104:107]
    v_add_f32 v11, v11, v52
    v_add_f32 v11, v11, v53
    v_mfma_f32_16x16x32_bf16 a[108:111], a[236:239], v[112:115], a[108:111]
    v_add_f32 v11, v11, v54
    v_add_f32 v11, v11, v55
    v_mfma_f32_16x16x32_bf16 a[112:115], a[240:243], v[112:115], a[112:115]
L_pad:
    v_accvgpr_read_b32 v208, a96
    v_accvgpr_read_b32 v209, a97
    v_mfma_f32_16x16x4_f32 v[116:119], v120, v11, 0
    buffer_store_dwordx4 v[68:71], v7, s[28:31], s55 offen offset:2176 nt
    v_accvgpr_read_b32 v210, a98
    v_accvgpr_read_b32 v211, a99
    v_accvgpr_read_b32 v212, a100
    v_accvgpr_read_b32 v213, a101
    v_mfma_f32_16x16x32_bf16 a[116:119], a[244:247], v[112:115], a[116:119]
    v_accvgpr_read_b32 v214, a102
    v_accvgpr_read_b32 v215, a103
    v_mfma_f32_16x16x32_bf16 a[120:123], a[248:251], v[112:115], a[120:123]
    v_accvgpr_read_b32 v216, a104
    v_accvgpr_read_b32 v217, a105
    v_mfma_f32_16x16x32_bf16 a[124:127], a[252:255], v[112:115], a[124:127]
    v_accvgpr_read_b32 v218, a106
    v_accvgpr_read_b32 v219, a107
    v_accvgpr_read_b32 v220, a108
    v_accvgpr_read_b32 v221, a109
    v_cmp_ngt_f32 vcc, 0x5d800000, v116
    v_rcp_f32 v11, v116
    s_or_b64 s[44:45], s[44:45], vcc
    v_accvgpr_read_b32 v222, a110
    v_accvgpr_read_b32 v223, a111
    v_pk_mul_f32 v[208:209], v[208:209], v[10:11] op_sel:[0,1] op_sel_hi:[1,1]
    v_pk_mul_f32 v[210:211], v[210:211], v[10:11] op_sel:[0,1] op_sel_hi:[1,1]
    v_pk_mul_f32 v[212:213], v[212:213], v[10:11] op_sel:[0,1] op_sel_hi:[1,1]
    v_pk_mul_f32 v[214:215], v[214:215], v[10:11] op_sel:[0,1] op_sel_hi:[1,1]
    v_pk_mul_f32 v[216:217], v[216:217], v[10:11] op_sel:[0,1] op_sel_hi:[1,1]
    v_pk_mul_f32 v[218:219], v[218:219], v[10:11] op_sel:[0,1] op_sel_hi:[1,1]
    v_pk_mul_f32 v[220:221], v[220:221], v[10:11] op_sel:[0,1] op_sel_hi:[1,1]
    v_pk_mul_f32 v[222:223], v[222:223], v[10:11] op_sel:[0,1] op_sel_hi:[1,1]
    v_cvt_pk_bf16_f32 v208, v208, v209
    v_cvt_pk_bf16_f32 v209, v210, v211
    v_mfma_f32_16x16x32_bf16 v[40:43], v[136:139], v[224:227], v[32:35]
    ds_write_b64 v1, v[208:209] offset:0
    v_cvt_pk_bf16_f32 v210, v212, v213
    v_cvt_pk_bf16_f32 v211, v214, v215
    v_mfma_f32_16x16x32_bf16 v[40:43], v[140:143], v[228:231], v[40:43]
    ds_write_b64 v1, v[210:211] offset:32
    v_cvt_pk_bf16_f32 v212, v216, v217
    v_cvt_pk_bf16_f32 v213, v218, v219
    v_mfma_f32_16x16x32_bf16 v[40:43], v[144:147], v[232:235], v[40:43]
    ds_write_b64 v1, v[212:213] offset:64
    v_cvt_pk_bf16_f32 v214, v220, v221
    v_cvt_pk_bf16_f32 v215, v222, v223
    v_mfma_f32_16x16x32_bf16 v[40:43], v[148:151], v[236:239], v[40:43]
    ds_write_b64 v1, v[214:215] offset:96
    v_mfma_f32_16x16x32_bf16 v[44:47], v[124:127], v[224:227], v[32:35]
    ds_read_b128 v[216:219], v0 offset:0
    v_mfma_f32_16x16x32_bf16 v[44:47], v[128:131], v[228:231], v[44:47]
    ds_read_b128 v[220:223], v0 offset:2176
    v_accvgpr_read_b32 v56, a112
    v_mfma_f32_16x16x32_bf16 v[44:47], v[132:135], v[232:235], v[44:47]
    v_accvgpr_read_b32 v57, a113
    v_accvgpr_read_b32 v58, a114
    v_accvgpr_read_b32 v59, a115
    v_accvgpr_read_b32 v60, a116
    v_mfma_f32_16x16x32_bf16 v[44:47], v[152:155], v[236:239], v[44:47]
    v_accvgpr_read_b32 v61, a117
    v_accvgpr_read_b32 v62, a118
    v_accvgpr_read_b32 v63, a119
    v_accvgpr_read_b32 v64, a120
    v_mfma_f32_16x16x32_bf16 a[128:131], a[192:195], v[104:107], a[128:131]
    v_accvgpr_read_b32 v65, a121
    v_accvgpr_read_b32 v66, a122
    v_accvgpr_read_b32 v67, a123
    v_accvgpr_read_b32 v68, a124
    v_accvgpr_read_b32 v69, a125
    v_accvgpr_read_b32 v70, a126
    v_accvgpr_read_b32 v71, a127
    v_pk_mul_f32 v[56:57], v[56:57], v[10:11] op_sel:[0,1] op_sel_hi:[1,1]
    v_pk_mul_f32 v[58:59], v[58:59], v[10:11] op_sel:[0,1] op_sel_hi:[1,1]
    v_pk_mul_f32 v[60:61], v[60:61], v[10:11] op_sel:[0,1] op_sel_hi:[1,1]
    v_pk_mul_f32 v[62:63], v[62:63], v[10:11] op_sel:[0,1] op_sel_hi:[1,1]
    v_pk_mul_f32 v[64:65], v[64:65], v[10:11] op_sel:[0,1] op_sel_hi:[1,1]
    v_pk_mul_f32 v[66:67], v[66:67], v[10:11] op_sel:[0,1] op_sel_hi:[1,1]
    v_pk_mul_f32 v[68:69], v[68:69], v[10:11] op_sel:[0,1] op_sel_hi:[1,1]
    v_pk_mul_f32 v[70:71], v[70:71], v[10:11] op_sel:[0,1] op_sel_hi:[1,1]
    s_waitcnt lgkmcnt(0)
    v_mfma_f32_16x16x32_bf16 a[132:135], a[196:199], v[104:107], a[132:135]
    buffer_store_dwordx4 v[216:219], v7, s[28:31], s56 offen offset:0 nt
    v_cvt_pk_bf16_f32 v56, v56, v57
    v_cvt_pk_bf16_f32 v57, v58, v59
    v_mfma_f32_16x16x32_bf16 a[136:139], a[200:203], v[104:107], a[136:139]
    ds_write_b64 v1, v[56:57] offset:128
    v_cvt_pk_bf16_f32 v58, v60, v61
    v_cvt_pk_bf16_f32 v59, v62, v63
    v_mfma_f32_16x16x32_bf16 a[140:143], a[204:207], v[104:107], a[140:143]
    ds_write_b64 v1, v[58:59] offset:160
    v_cvt_pk_bf16_f32 v60, v64, v65
    v_cvt_pk_bf16_f32 v61, v66, v67
    v_mfma_f32_16x16x32_bf16 a[144:147], a[208:211], v[104:107], a[144:147]
    ds_write_b64 v1, v[60:61] offset:192
    v_cvt_pk_bf16_f32 v62, v68, v69
    v_cvt_pk_bf16_f32 v63, v70, v71
    v_mfma_f32_16x16x32_bf16 a[148:151], a[212:215], v[104:107], a[148:151]
    ds_write_b64 v1, v[62:63] offset:224
    v_mfma_f32_16x16x32_bf16 a[152:155], a[216:219], v[104:107], a[152:155]
    ds_read_b128 v[64:67], v0 offset:128
    v_mfma_f32_16x16x32_bf16 a[156:159], a[220:223], v[104:107], a[156:159]
    ds_read_b128 v[68:71], v0 offset:2304
    buffer_store_dwordx4 v[220:223], v7, s[28:31], s56 offen offset:2048 nt
    v_exp_f32 v84, v84
    v_exp_f32 v85, v85
    v_exp_f32 v86, v86
    v_exp_f32 v87, v87
    v_cvt_pk_bf16_f32 v110, v84, v85
    v_cvt_pk_bf16_f32 v111, v86, v87
    v_add_f32 v13, v13, v84
    v_add_f32 v13, v13, v85
    v_add_f32 v13, v13, v86
    v_add_f32 v13, v13, v87
    v_exp_f32 v40, v40
    v_exp_f32 v41, v41
    v_exp_f32 v42, v42
    v_exp_f32 v43, v43
    v_cvt_pk_bf16_f32 v156, v40, v41
    v_exp_f32 v44, v44
    v_exp_f32 v45, v45
    v_cvt_pk_bf16_f32 v157, v42, v43
    v_exp_f32 v46, v46
    v_exp_f32 v47, v47
    v_cvt_pk_bf16_f32 v158, v44, v45
    v_add_f32 v12, v12, v40
    v_cvt_pk_bf16_f32 v159, v46, v47
    s_waitcnt lgkmcnt(0)
    v_add_f32 v12, v12, v41
    v_mfma_f32_16x16x32_bf16 a[128:131], a[224:227], v[156:159], a[128:131]
    buffer_store_dwordx4 v[64:67], v7, s[28:31], s56 offen offset:128 nt
    v_mfma_f32_16x16x32_bf16 a[132:135], a[228:231], v[156:159], a[132:135]
    v_add_f32 v12, v12, v42
    v_add_f32 v12, v12, v43
    v_mfma_f32_16x16x32_bf16 a[136:139], a[232:235], v[156:159], a[136:139]
    v_add_f32 v12, v12, v44
    v_add_f32 v12, v12, v45
    v_mfma_f32_16x16x32_bf16 a[140:143], a[236:239], v[156:159], a[140:143]
    v_add_f32 v12, v12, v46
    v_add_f32 v12, v12, v47
    v_mfma_f32_16x16x32_bf16 a[144:147], a[240:243], v[156:159], a[144:147]
    v_accvgpr_read_b32 v224, a128
    v_accvgpr_read_b32 v225, a129
    v_mfma_f32_16x16x4_f32 v[116:119], v120, v12, 0
    buffer_store_dwordx4 v[68:71], v7, s[28:31], s56 offen offset:2176 nt
    v_accvgpr_read_b32 v226, a130
    v_accvgpr_read_b32 v227, a131
    v_accvgpr_read_b32 v228, a132
    v_accvgpr_read_b32 v229, a133
    v_mfma_f32_16x16x32_bf16 a[148:151], a[244:247], v[156:159], a[148:151]
    v_accvgpr_read_b32 v230, a134
    v_accvgpr_read_b32 v231, a135
    v_mfma_f32_16x16x32_bf16 a[152:155], a[248:251], v[156:159], a[152:155]
    v_accvgpr_read_b32 v232, a136
    v_accvgpr_read_b32 v233, a137
    v_mfma_f32_16x16x32_bf16 a[156:159], a[252:255], v[156:159], a[156:159]
    v_accvgpr_read_b32 v234, a138
    v_accvgpr_read_b32 v235, a139
    v_accvgpr_read_b32 v236, a140
    v_accvgpr_read_b32 v237, a141
    v_cmp_ngt_f32 vcc, 0x5d800000, v116
    v_rcp_f32 v12, v116
    s_or_b64 s[44:45], s[44:45], vcc
    v_accvgpr_read_b32 v238, a142
    v_accvgpr_read_b32 v239, a143
    v_pk_mul_f32 v[224:225], v[224:225], v[12:13] op_sel_hi:[1,0]
    v_pk_mul_f32 v[226:227], v[226:227], v[12:13] op_sel_hi:[1,0]
    v_pk_mul_f32 v[228:229], v[228:229], v[12:13] op_sel_hi:[1,0]
    v_pk_mul_f32 v[230:231], v[230:231], v[12:13] op_sel_hi:[1,0]
    v_pk_mul_f32 v[232:233], v[232:233], v[12:13] op_sel_hi:[1,0]
    v_pk_mul_f32 v[234:235], v[234:235], v[12:13] op_sel_hi:[1,0]
    v_pk_mul_f32 v[236:237], v[236:237], v[12:13] op_sel_hi:[1,0]
    v_pk_mul_f32 v[238:239], v[238:239], v[12:13] op_sel_hi:[1,0]
    v_cvt_pk_bf16_f32 v224, v224, v225
    v_cvt_pk_bf16_f32 v225, v226, v227
    v_mfma_f32_16x16x32_bf16 v[48:51], v[136:139], v[240:243], v[36:39]
    ds_write_b64 v1, v[224:225] offset:4352
    v_cvt_pk_bf16_f32 v226, v228, v229
    v_cvt_pk_bf16_f32 v227, v230, v231
    v_mfma_f32_16x16x32_bf16 v[48:51], v[140:143], v[244:247], v[48:51]
    ds_write_b64 v1, v[226:227] offset:4384
    v_cvt_pk_bf16_f32 v228, v232, v233
    v_cvt_pk_bf16_f32 v229, v234, v235
    v_mfma_f32_16x16x32_bf16 v[48:51], v[144:147], v[248:251], v[48:51]
    ds_write_b64 v1, v[228:229] offset:4416
    v_cvt_pk_bf16_f32 v230, v236, v237
    v_cvt_pk_bf16_f32 v231, v238, v239
    v_mfma_f32_16x16x32_bf16 v[48:51], v[148:151], v[252:255], v[48:51]
    ds_write_b64 v1, v[230:231] offset:4448
    v_mfma_f32_16x16x32_bf16 v[52:55], v[124:127], v[240:243], v[36:39]
    ds_read_b128 v[232:235], v0 offset:4352
    v_mfma_f32_16x16x32_bf16 v[52:55], v[128:131], v[244:247], v[52:55]
    ds_read_b128 v[236:239], v0 offset:6528
    v_accvgpr_read_b32 v56, a144
    v_mfma_f32_16x16x32_bf16 v[52:55], v[132:135], v[248:251], v[52:55]
    v_accvgpr_read_b32 v57, a145
    v_accvgpr_read_b32 v58, a146
    v_accvgpr_read_b32 v59, a147
    v_accvgpr_read_b32 v60, a148
    v_mfma_f32_16x16x32_bf16 v[52:55], v[152:155], v[252:255], v[52:55]
    v_accvgpr_read_b32 v61, a149
    v_accvgpr_read_b32 v62, a150
    v_accvgpr_read_b32 v63, a151
    v_accvgpr_read_b32 v64, a152
    v_mfma_f32_16x16x32_bf16 a[160:163], a[192:195], v[108:111], a[160:163]
    v_accvgpr_read_b32 v65, a153
    v_accvgpr_read_b32 v66, a154
    v_accvgpr_read_b32 v67, a155
    v_accvgpr_read_b32 v68, a156
    v_accvgpr_read_b32 v69, a157
    v_accvgpr_read_b32 v70, a158
    v_accvgpr_read_b32 v71, a159
    v_pk_mul_f32 v[56:57], v[56:57], v[12:13] op_sel_hi:[1,0]
    v_pk_mul_f32 v[58:59], v[58:59], v[12:13] op_sel_hi:[1,0]
    v_pk_mul_f32 v[60:61], v[60:61], v[12:13] op_sel_hi:[1,0]
    v_pk_mul_f32 v[62:63], v[62:63], v[12:13] op_sel_hi:[1,0]
    v_pk_mul_f32 v[64:65], v[64:65], v[12:13] op_sel_hi:[1,0]
    v_pk_mul_f32 v[66:67], v[66:67], v[12:13] op_sel_hi:[1,0]
    v_pk_mul_f32 v[68:69], v[68:69], v[12:13] op_sel_hi:[1,0]
    v_pk_mul_f32 v[70:71], v[70:71], v[12:13] op_sel_hi:[1,0]
    s_waitcnt lgkmcnt(0)
    v_mfma_f32_16x16x32_bf16 a[164:167], a[196:199], v[108:111], a[164:167]
    buffer_store_dwordx4 v[232:235], v7, s[28:31], s57 offen offset:0 nt
    v_cvt_pk_bf16_f32 v56, v56, v57
    v_cvt_pk_bf16_f32 v57, v58, v59
    v_mfma_f32_16x16x32_bf16 a[168:171], a[200:203], v[108:111], a[168:171]
    ds_write_b64 v1, v[56:57] offset:4480
    v_cvt_pk_bf16_f32 v58, v60, v61
    v_cvt_pk_bf16_f32 v59, v62, v63
    v_mfma_f32_16x16x32_bf16 a[172:175], a[204:207], v[108:111], a[172:175]
    ds_write_b64 v1, v[58:59] offset:4512
    v_cvt_pk_bf16_f32 v60, v64, v65
    v_cvt_pk_bf16_f32 v61, v66, v67
    v_mfma_f32_16x16x32_bf16 a[176:179], a[208:211], v[108:111], a[176:179]
    ds_write_b64 v1, v[60:61] offset:4544
    v_cvt_pk_bf16_f32 v62, v68, v69
    v_cvt_pk_bf16_f32 v63, v70, v71
    v_mfma_f32_16x16x32_bf16 a[180:183], a[212:215], v[108:111], a[180:183]
    ds_write_b64 v1, v[62:63] offset:4576
    v_mfma_f32_16x16x32_bf16 a[184:187], a[216:219], v[108:111], a[184:187]
    ds_read_b128 v[64:67], v0 offset:4480
    v_mfma_f32_16x16x32_bf16 a[188:191], a[220:223], v[108:111], a[188:191]
    ds_read_b128 v[68:71], v0 offset:6656
    buffer_store_dwordx4 v[236:239], v7, s[28:31], s57 offen offset:2048 nt
    v_exp_f32 v48, v48
    v_exp_f32 v49, v49
    v_exp_f32 v50, v50
    v_exp_f32 v51, v51
    v_cvt_pk_bf16_f32 v112, v48, v49
    v_exp_f32 v52, v52
    v_exp_f32 v53, v53
    v_cvt_pk_bf16_f32 v113, v50, v51
    v_exp_f32 v54, v54
    v_exp_f32 v55, v55
    v_cvt_pk_bf16_f32 v114, v52, v53
    v_add_f32 v13, v13, v48
    v_cvt_pk_bf16_f32 v115, v54, v55
    s_waitcnt lgkmcnt(0)
    v_add_f32 v13, v13, v49
    v_mfma_f32_16x16x32_bf16 a[160:163], a[224:227], v[112:115], a[160:163]
    buffer_store_dwordx4 v[64:67], v7, s[28:31], s57 offen offset:128 nt
    v_mfma_f32_16x16x32_bf16 a[164:167], a[228:231], v[112:115], a[164:167]
    v_add_f32 v13, v13, v50
    v_add_f32 v13, v13, v51
    v_mfma_f32_16x16x32_bf16 a[168:171], a[232:235], v[112:115], a[168:171]
    v_add_f32 v13, v13, v52
    v_add_f32 v13, v13, v53
    v_mfma_f32_16x16x32_bf16 a[172:175], a[236:239], v[112:115], a[172:175]
    v_add_f32 v13, v13, v54
    v_add_f32 v13, v13, v55
    v_mfma_f32_16x16x32_bf16 a[176:179], a[240:243], v[112:115], a[176:179]
    v_accvgpr_read_b32 v240, a160
    v_accvgpr_read_b32 v241, a161
    v_mfma_f32_16x16x4_f32 v[116:119], v120, v13, 0
    buffer_store_dwordx4 v[68:71], v7, s[28:31], s57 offen offset:2176 nt
    v_accvgpr_read_b32 v242, a162
    v_accvgpr_read_b32 v243, a163
    v_accvgpr_read_b32 v244, a164
    v_accvgpr_read_b32 v245, a165
    v_mfma_f32_16x16x32_bf16 a[180:183], a[244:247], v[112:115], a[180:183]
    v_accvgpr_read_b32 v246, a166
    v_accvgpr_read_b32 v247, a167
    v_mfma_f32_16x16x32_bf16 a[184:187], a[248:251], v[112:115], a[184:187]
    v_accvgpr_read_b32 v248, a168
    v_accvgpr_read_b32 v249, a169
    v_mfma_f32_16x16x32_bf16 a[188:191], a[252:255], v[112:115], a[188:191]
    v_accvgpr_read_b32 v250, a170
    v_accvgpr_read_b32 v251, a171
    v_accvgpr_read_b32 v252, a172
    v_accvgpr_read_b32 v253, a173
    v_cmp_ngt_f32 vcc, 0x5d800000, v116
    v_rcp_f32 v13, v116
    s_or_b64 s[44:45], s[44:45], vcc
    s_cselect_b32 s42, 1, 0
    v_mov_b32 v14, s42
    v_accvgpr_read_b32 v254, a174
    v_accvgpr_read_b32 v255, a175
    v_pk_mul_f32 v[240:241], v[240:241], v[12:13] op_sel:[0,1] op_sel_hi:[1,1]
    v_pk_mul_f32 v[242:243], v[242:243], v[12:13] op_sel:[0,1] op_sel_hi:[1,1]
    v_pk_mul_f32 v[244:245], v[244:245], v[12:13] op_sel:[0,1] op_sel_hi:[1,1]
    v_pk_mul_f32 v[246:247], v[246:247], v[12:13] op_sel:[0,1] op_sel_hi:[1,1]
    v_pk_mul_f32 v[248:249], v[248:249], v[12:13] op_sel:[0,1] op_sel_hi:[1,1]
    v_pk_mul_f32 v[250:251], v[250:251], v[12:13] op_sel:[0,1] op_sel_hi:[1,1]
    v_pk_mul_f32 v[252:253], v[252:253], v[12:13] op_sel:[0,1] op_sel_hi:[1,1]
    v_pk_mul_f32 v[254:255], v[254:255], v[12:13] op_sel:[0,1] op_sel_hi:[1,1]
    v_cvt_pk_bf16_f32 v240, v240, v241
    v_cvt_pk_bf16_f32 v241, v242, v243
    ds_write_b64 v1, v[240:241] offset:8704
    v_cvt_pk_bf16_f32 v242, v244, v245
    v_cvt_pk_bf16_f32 v243, v246, v247
    ds_write_b64 v1, v[242:243] offset:8736
    v_cvt_pk_bf16_f32 v244, v248, v249
    v_cvt_pk_bf16_f32 v245, v250, v251
    ds_write_b64 v1, v[244:245] offset:8768
    v_cvt_pk_bf16_f32 v246, v252, v253
    v_cvt_pk_bf16_f32 v247, v254, v255
    ds_write_b64 v1, v[246:247] offset:8800
    ds_read_b128 v[248:251], v0 offset:8704
    ds_read_b128 v[252:255], v0 offset:10880
    v_accvgpr_read_b32 v56, a176
    v_accvgpr_read_b32 v57, a177
    v_accvgpr_read_b32 v58, a178
    v_accvgpr_read_b32 v59, a179
    v_accvgpr_read_b32 v60, a180
    v_accvgpr_read_b32 v61, a181
    v_accvgpr_read_b32 v62, a182
    v_accvgpr_read_b32 v63, a183
    v_accvgpr_read_b32 v64, a184
    v_accvgpr_read_b32 v65, a185
    v_accvgpr_read_b32 v66, a186
    v_accvgpr_read_b32 v67, a187
    v_accvgpr_read_b32 v68, a188
    v_accvgpr_read_b32 v69, a189
    v_accvgpr_read_b32 v70, a190
    v_accvgpr_read_b32 v71, a191
    v_pk_mul_f32 v[56:57], v[56:57], v[12:13] op_sel:[0,1] op_sel_hi:[1,1]
    v_pk_mul_f32 v[58:59], v[58:59], v[12:13] op_sel:[0,1] op_sel_hi:[1,1]
    v_pk_mul_f32 v[60:61], v[60:61], v[12:13] op_sel:[0,1] op_sel_hi:[1,1]
    v_pk_mul_f32 v[62:63], v[62:63], v[12:13] op_sel:[0,1] op_sel_hi:[1,1]
    v_pk_mul_f32 v[64:65], v[64:65], v[12:13] op_sel:[0,1] op_sel_hi:[1,1]
    v_pk_mul_f32 v[66:67], v[66:67], v[12:13] op_sel:[0,1] op_sel_hi:[1,1]
    v_pk_mul_f32 v[68:69], v[68:69], v[12:13] op_sel:[0,1] op_sel_hi:[1,1]
    v_pk_mul_f32 v[70:71], v[70:71], v[12:13] op_sel:[0,1] op_sel_hi:[1,1]
    s_waitcnt lgkmcnt(0)
    buffer_store_dwordx4 v[248:251], v7, s[28:31], s58 offen offset:0 nt
    v_cvt_pk_bf16_f32 v56, v56, v57
    v_cvt_pk_bf16_f32 v57, v58, v59
    ds_write_b64 v1, v[56:57] offset:8832
    v_cvt_pk_bf16_f32 v58, v60, v61
    v_cvt_pk_bf16_f32 v59, v62, v63
    ds_write_b64 v1, v[58:59] offset:8864
    v_cvt_pk_bf16_f32 v60, v64, v65
    v_cvt_pk_bf16_f32 v61, v66, v67
    ds_write_b64 v1, v[60:61] offset:8896
    v_cvt_pk_bf16_f32 v62, v68, v69
    v_cvt_pk_bf16_f32 v63, v70, v71
    ds_write_b64 v1, v[62:63] offset:8928
    ds_write_b32 v15, v14
    ds_read_b128 v[64:67], v0 offset:8832
    ds_read_b128 v[68:71], v0 offset:11008
    buffer_store_dwordx4 v[252:255], v7, s[28:31], s58 offen offset:2048 nt
    s_waitcnt lgkmcnt(0)
    buffer_store_dwordx4 v[64:67], v7, s[28:31], s58 offen offset:128 nt
    buffer_store_dwordx4 v[68:71], v7, s[28:31], s58 offen offset:2176 nt
    s_waitcnt lgkmcnt(0)
    s_barrier
    v_mov_b32 v15, 154112
    ds_read_b128 v[16:19], v15
    s_waitcnt lgkmcnt(0)
    v_or_b32 v16, v16, v17
    v_or3_b32 v16, v16, v18, v19
    s_nop 1
    v_readfirstlane_b32 s42, v16
    s_nop 3
    s_andn2_b32 s42, s42, s50
    s_cbranch_scc1 L_fallback
L_end:
    s_endpgm
L_lpre:
    v_add_f32 v12, v12, v112
    v_add_f32 v12, v12, v113
    v_add_f32 v12, v12, v114
    v_add_f32 v12, v12, v115
    v_add_f32 v12, v12, v116
    v_add_f32 v12, v12, v117
    v_add_f32 v12, v12, v118
    v_add_f32 v12, v12, v119
    v_exp_f32 v56, v56
    v_exp_f32 v57, v57
    v_exp_f32 v58, v58
    v_exp_f32 v59, v59
    v_exp_f32 v80, v80
    v_exp_f32 v81, v81
    v_exp_f32 v82, v82
    v_exp_f32 v83, v83
    v_cvt_pk_bf16_f32 v128, v56, v57
    v_cvt_pk_bf16_f32 v129, v58, v59
    v_cvt_pk_bf16_f32 v130, v80, v81
    v_cvt_pk_bf16_f32 v131, v82, v83
    v_add_f32 v12, v12, v56
    v_add_f32 v12, v12, v57
    v_add_f32 v12, v12, v58
    v_add_f32 v12, v12, v59
    v_add_f32 v12, v12, v80
    v_add_f32 v12, v12, v81
    v_add_f32 v12, v12, v82
    v_add_f32 v12, v12, v83
L_lstart:
    v_subrev_u32 v156, 1536, v2
    s_add_u32 s42, s3, 16384
    s_and_b32 s42, s42, 0x3ffff
    s_mov_b32 m0, 67584
    s_nop 0
    buffer_load_dwordx4 v156, s[24:27], s42 offen offset:0 nt lds
    s_mov_b32 m0, 68384
    s_nop 0
    buffer_load_dwordx4 v156, s[24:27], s42 offen offset:256 nt lds
    s_mov_b32 m0, 69184
    s_nop 0
    buffer_load_dwordx4 v156, s[24:27], s42 offen offset:512 nt lds
    s_mov_b32 m0, 69984
    s_nop 0
    buffer_load_dwordx4 v156, s[24:27], s42 offen offset:768 nt lds
    s_mov_b32 m0, 70784
    s_nop 0
    buffer_load_dwordx4 v156, s[24:27], s42 offen offset:1024 nt lds
    s_mov_b32 m0, 71584
    s_nop 0
    buffer_load_dwordx4 v156, s[24:27], s42 offen offset:1280 nt lds
    s_mov_b32 m0, 72384
    s_nop 0
    buffer_load_dwordx4 v156, s[24:27], s42 offen offset:1536 nt lds
    s_mov_b32 m0, 73184
    s_nop 0
    buffer_load_dwordx4 v156, s[24:27], s42 offen offset:1792 nt lds
    s_add_u32 s42, s3, 24576
    s_and_b32 s42, s42, 0x3ffff
    s_mov_b32 m0, 25344
    s_nop 0
    buffer_load_dwordx4 v156, s[20:23], s42 offen offset:0 nt lds
    s_mov_b32 m0, 26144
    s_nop 0
    buffer_load_dwordx4 v156, s[20:23], s42 offen offset:256 nt lds
    s_mov_b32 m0, 26944
    s_nop 0
    buffer_load_dwordx4 v156, s[20:23], s42 offen offset:512 nt lds
    s_mov_b32 m0, 27744
    s_nop 0
    buffer_load_dwordx4 v156, s[20:23], s42 offen offset:768 nt lds
    s_mov_b32 m0, 28544
    s_nop 0
    buffer_load_dwordx4 v156, s[20:23], s42 offen offset:1024 nt lds
    s_mov_b32 m0, 29344
    s_nop 0
    buffer_load_dwordx4 v156, s[20:23], s42 offen offset:1280 nt lds
    s_mov_b32 m0, 30144
    s_nop 0
    buffer_load_dwordx4 v156, s[20:23], s42 offen offset:1536 nt lds
    s_mov_b32 m0, 30944
    s_nop 0
    buffer_load_dwordx4 v156, s[20:23], s42 offen offset:1792 nt lds
    v_mov_b32 v240, 0
    v_mov_b32 v241, 0
    v_mov_b32 v242, 0
    v_mov_b32 v243, 0
    v_mov_b32 v244, 0
    v_mov_b32 v245, 0
    v_mov_b32 v246, 0
    v_mov_b32 v247, 0
    v_mov_b32 v248, 0
    v_mov_b32 v249, 0
    v_mov_b32 v250, 0
    v_mov_b32 v251, 0
    v_mov_b32 v252, 0
    v_mov_b32 v253, 0
    v_mov_b32 v254, 0
    v_mov_b32 v255, 0
    v_mov_b32 v36, 0xff800000
    v_mov_b32 v84, 0xff800000
    v_mov_b32 v60, 0
    v_mov_b32 v37, 0xff800000
    v_mov_b32 v85, 0xff800000
    v_mov_b32 v61, 0
    v_mov_b32 v38, 0xff800000
    v_mov_b32 v86, 0xff800000
    v_mov_b32 v62, 0
    v_mov_b32 v39, 0xff800000
    v_mov_b32 v87, 0xff800000
    v_mov_b32 v63, 0
    s_mov_b32 s38, 40960
    s_add_u32 s32, s3, 40960
    s_and_b32 s32, s32, 0x3ffff
    s_add_u32 s33, s3, 32768
    s_and_b32 s33, s33, 0x3ffff
    s_mov_b32 s34, 42240
    s_mov_b32 s35, 84480
    s_waitcnt vmcnt(16)
    s_barrier
    ds_read_b128 v[148:151], v5 offset:192
    ds_read_b128 v[144:147], v5 offset:128
    ds_read_b128 v[140:143], v5 offset:64
    ds_read_b128 v[136:139], v5 offset:0
    ds_read_b64_tr_b16 a[224:225], v6 offset:8448
    ds_read_b64_tr_b16 a[226:227], v6 offset:8960
    ds_read_b64_tr_b16 a[228:229], v6 offset:8480
    s_add_u32 s42, s3, 24576
    s_and_b32 s42, s42, 0x3ffff
    s_mov_b32 m0, 76032
    s_nop 0
    buffer_load_dwordx4 v156, s[24:27], s42 offen offset:0 nt lds
    s_mov_b32 m0, 76832
    s_nop 0
    buffer_load_dwordx4 v156, s[24:27], s42 offen offset:256 nt lds
    s_mov_b32 m0, 77632
    s_nop 0
    buffer_load_dwordx4 v156, s[24:27], s42 offen offset:512 nt lds
    s_mov_b32 m0, 78432
    s_nop 0
    buffer_load_dwordx4 v156, s[24:27], s42 offen offset:768 nt lds
    s_mov_b32 m0, 79232
    s_nop 0
    buffer_load_dwordx4 v156, s[24:27], s42 offen offset:1024 nt lds
    s_mov_b32 m0, 80032
    s_nop 0
    buffer_load_dwordx4 v156, s[24:27], s42 offen offset:1280 nt lds
    s_mov_b32 m0, 80832
    s_nop 0
    buffer_load_dwordx4 v156, s[24:27], s42 offen offset:1536 nt lds
    s_mov_b32 m0, 81632
    s_nop 0
    buffer_load_dwordx4 v156, s[24:27], s42 offen offset:1792 nt lds
    s_add_u32 s42, s3, 32768
    s_and_b32 s42, s42, 0x3ffff
    s_mov_b32 m0, 33792
    s_nop 0
    buffer_load_dwordx4 v156, s[20:23], s42 offen offset:0 nt lds
    s_mov_b32 m0, 34592
    s_nop 0
    buffer_load_dwordx4 v156, s[20:23], s42 offen offset:256 nt lds
    s_mov_b32 m0, 35392
    s_nop 0
    buffer_load_dwordx4 v156, s[20:23], s42 offen offset:512 nt lds
    s_mov_b32 m0, 36192
    s_nop 0
    buffer_load_dwordx4 v156, s[20:23], s42 offen offset:768 nt lds
    s_mov_b32 m0, 36992
    s_nop 0
    buffer_load_dwordx4 v156, s[20:23], s42 offen offset:1024 nt lds
    s_mov_b32 m0, 37792
    s_nop 0
    buffer_load_dwordx4 v156, s[20:23], s42 offen offset:1280 nt lds
    s_mov_b32 m0, 38592
    s_nop 0
    buffer_load_dwordx4 v156, s[20:23], s42 offen offset:1536 nt lds
    s_mov_b32 m0, 39392
    s_nop 0
    buffer_load_dwordx4 v156, s[20:23], s42 offen offset:1792 nt lds
    s_lshl_b32 s43, s49, 2
    s_add_u32 s43, s43, 154112
    v_mov_b32 v15, s43
    s_waitcnt lgkmcnt(3)
    v_mfma_f32_16x16x32_bf16 v[52:55], v[136:139], v[208:211], v[28:31]
    s_branch L_lloop_mid
.p2align 6
L_lloop:
    v_exp_f32 v76, v76
    v_mfma_f32_16x16x32_bf16 v[40:43], v[140:143], v[164:167], v[40:43]
    s_add_u32 m0, s35, 0
    v_cvt_pk_bf16_f32 v100, v52, v53
    v_cvt_pk_bf16_f32 v101, v54, v55
    v_mfma_f32_16x16x32_bf16 v[40:43], v[144:147], v[168:171], v[40:43]
    buffer_load_dwordx4 v156, s[24:27], s33 offen offset:0 nt lds
    v_exp_f32 v77, v77
    v_mfma_f32_16x16x32_bf16 v[40:43], v[148:151], v[172:175], v[40:43]
    ds_read_b64_tr_b16 a[198:199], v6 offset:544
    v_cvt_pk_bf16_f32 v104, v56, v57
    v_mfma_f32_16x16x32_bf16 v[44:47], v[148:151], v[188:191], v[20:23]
    s_add_u32 m0, s35, 800
    v_exp_f32 v78, v78
    v_mfma_f32_16x16x32_bf16 v[44:47], v[144:147], v[184:187], v[44:47]
    buffer_load_dwordx4 v156, s[24:27], s33 offen offset:256 nt lds
    v_cvt_pk_bf16_f32 v105, v58, v59
    v_mfma_f32_16x16x32_bf16 v[44:47], v[140:143], v[180:183], v[44:47]
    v_exp_f32 v79, v79
    v_mfma_f32_16x16x32_bf16 v[44:47], v[136:139], v[176:179], v[44:47]
    ds_read_b64_tr_b16 a[200:201], v6 offset:64
    v_mfma_f32_16x16x32_bf16 v[48:51], v[136:139], v[192:195], v[24:27]
    s_add_u32 m0, s35, 1600
    v_exp_f32 v80, v80
    v_mfma_f32_16x16x32_bf16 v[48:51], v[140:143], v[196:199], v[48:51]
    buffer_load_dwordx4 v156, s[24:27], s33 offen offset:512 nt lds
    v_cvt_pk_bf16_f32 v99, v74, v75
    v_cvt_pk_bf16_f32 v102, v76, v77
    v_mfma_f32_16x16x32_bf16 v[48:51], v[144:147], v[200:203], v[48:51]
    v_exp_f32 v81, v81
    v_mfma_f32_16x16x32_bf16 v[48:51], v[148:151], v[204:207], v[48:51]
    ds_read_b64_tr_b16 a[202:203], v6 offset:576
    v_cvt_pk_bf16_f32 v103, v78, v79
    v_mfma_f32_16x16x32_bf16 v[52:55], v[148:151], v[220:223], v[28:31]
    s_add_u32 m0, s35, 2400
    v_exp_f32 v82, v82
    v_mfma_f32_16x16x32_bf16 v[52:55], v[144:147], v[216:219], v[52:55]
    buffer_load_dwordx4 v156, s[24:27], s33 offen offset:768 nt lds
    v_cvt_pk_bf16_f32 v106, v80, v81
    v_add_f32 v10, v10, v75
    v_mfma_f32_16x16x32_bf16 v[52:55], v[140:143], v[212:215], v[52:55]
    v_exp_f32 v83, v83
    v_mfma_f32_16x16x32_bf16 v[52:55], v[136:139], v[208:211], v[52:55]
    ds_read_b64_tr_b16 a[204:205], v6 offset:96
    s_add_u32 m0, s35, 3200
    v_add_f32 v11, v11, v76
    v_mfma_f32_16x16x32_bf16 v[56:59], v[136:139], v[224:227], v[32:35]
    buffer_load_dwordx4 v156, s[24:27], s33 offen offset:1024 nt lds
    v_mfma_f32_16x16x32_bf16 v[56:59], v[140:143], v[228:231], v[56:59]
    v_cvt_pk_bf16_f32 v107, v82, v83
    v_add_f32 v11, v11, v77
    v_mfma_f32_16x16x32_bf16 v[56:59], v[144:147], v[232:235], v[56:59]
    s_waitcnt lgkmcnt(5)
    v_mfma_f32_16x16x32_bf16 v[56:59], v[148:151], v[236:239], v[56:59]
    ds_read_b64_tr_b16 a[206:207], v6 offset:608
    ds_read_b128 v[148:151], v5 offset:9152
    v_add_f32 v11, v11, v78
    v_add_f32 v11, v11, v79
    v_add_f32 v12, v12, v80
    v_mfma_f32_16x16x32_bf16 a[0:3], a[224:227], v[112:115], a[0:3]
    s_add_u32 m0, s35, 4000
    v_exp_f32 v52, v52
    v_mfma_f32_16x16x32_bf16 a[0:3], a[192:195], v[88:91], a[0:3]
    buffer_load_dwordx4 v156, s[24:27], s33 offen offset:1280 nt lds
    v_add_f32 v12, v12, v81
    v_mfma_f32_16x16x32_bf16 a[32:35], a[192:195], v[92:95], a[32:35]
    v_exp_f32 v53, v53
    v_mfma_f32_16x16x32_bf16 a[32:35], a[224:227], v[116:119], a[32:35]
    ds_read_b128 v[144:147], v5 offset:9088
    s_add_u32 m0, s35, 4800
    v_add_f32 v12, v12, v82
    v_mfma_f32_16x16x32_bf16 a[64:67], a[224:227], v[120:123], a[64:67]
    buffer_load_dwordx4 v156, s[24:27], s33 offen offset:1536 nt lds
    v_exp_f32 v54, v54
    v_mfma_f32_16x16x32_bf16 a[64:67], a[192:195], v[96:99], a[64:67]
    s_waitcnt lgkmcnt(6)
    v_cvt_pk_bf16_f32 v124, v52, v53
    v_add_f32 v12, v12, v83
    v_mfma_f32_16x16x32_bf16 a[68:71], a[196:199], v[96:99], a[68:71]
    s_add_u32 m0, s35, 5600
    v_exp_f32 v55, v55
    v_mfma_f32_16x16x32_bf16 a[68:71], a[228:231], v[120:123], a[68:71]
    ds_read_b128 v[140:143], v5 offset:9024
    v_mfma_f32_16x16x32_bf16 a[36:39], a[228:231], v[116:119], a[36:39]
    v_exp_f32 v56, v56
    v_mfma_f32_16x16x32_bf16 a[36:39], a[196:199], v[92:95], a[36:39]
    buffer_load_dwordx4 v156, s[24:27], s33 offen offset:1792 nt lds
    v_cvt_pk_bf16_f32 v125, v54, v55
    v_mfma_f32_16x16x32_bf16 a[4:7], a[196:199], v[88:91], a[4:7]
    s_waitcnt lgkmcnt(5)
    v_exp_f32 v57, v57
    v_mfma_f32_16x16x32_bf16 a[4:7], a[228:231], v[112:115], a[4:7]
    ds_read_b128 v[136:139], v5 offset:8960
    v_mfma_f32_16x16x32_bf16 a[8:11], a[232:235], v[112:115], a[8:11]
    s_add_u32 m0, s34, 0
    v_exp_f32 v58, v58
    v_mfma_f32_16x16x32_bf16 a[8:11], a[200:203], v[88:91], a[8:11]
    buffer_load_dwordx4 v156, s[20:23], s32 offen offset:0 nt lds
    v_cvt_pk_bf16_f32 v128, v56, v57
    v_mfma_f32_16x16x32_bf16 a[40:43], a[200:203], v[92:95], a[40:43]
    s_add_u32 m0, s34, 800
    v_exp_f32 v59, v59
    v_mfma_f32_16x16x32_bf16 a[40:43], a[232:235], v[116:119], a[40:43]
    ds_read_b64_tr_b16 a[208:209], v6 offset:128
    v_add_f32 v11, v11, v52
    v_mfma_f32_16x16x32_bf16 a[72:75], a[232:235], v[120:123], a[72:75]
    buffer_load_dwordx4 v156, s[20:23], s32 offen offset:256 nt lds
    v_mfma_f32_16x16x32_bf16 a[72:75], a[200:203], v[96:99], a[72:75]
    s_waitcnt lgkmcnt(5)
    s_add_u32 m0, s34, 1600
    v_cvt_pk_bf16_f32 v129, v58, v59
    v_add_f32 v11, v11, v53
    v_mfma_f32_16x16x32_bf16 a[76:79], a[204:207], v[96:99], a[76:79]
    buffer_load_dwordx4 v156, s[20:23], s32 offen offset:512 nt lds
    v_mfma_f32_16x16x32_bf16 a[76:79], a[236:239], v[120:123], a[76:79]
    ds_read_b64_tr_b16 a[210:211], v6 offset:640
    v_add_f32 v11, v11, v54
    v_mfma_f32_16x16x32_bf16 a[44:47], a[236:239], v[116:119], a[44:47]
    v_mfma_f32_16x16x32_bf16 a[44:47], a[204:207], v[92:95], a[44:47]
    s_add_u32 m0, s34, 2400
    v_add_f32 v11, v11, v55
    v_mfma_f32_16x16x32_bf16 a[12:15], a[204:207], v[88:91], a[12:15]
    buffer_load_dwordx4 v156, s[20:23], s32 offen offset:768 nt lds
    s_waitcnt lgkmcnt(2)
    v_mfma_f32_16x16x32_bf16 a[12:15], a[236:239], v[112:115], a[12:15]
    ds_read_b64_tr_b16 a[212:213], v6 offset:160
    v_add_f32 v12, v12, v56
    v_mfma_f32_16x16x32_bf16 v[76:79], v[136:139], v[208:211], v[28:31]
    v_exp_f32 v40, v40
    v_mfma_f32_16x16x32_bf16 v[76:79], v[140:143], v[212:215], v[76:79]
    s_add_u32 m0, s34, 3200
    v_add_f32 v12, v12, v57
    v_mfma_f32_16x16x32_bf16 v[76:79], v[144:147], v[216:219], v[76:79]
    buffer_load_dwordx4 v156, s[20:23], s32 offen offset:1024 nt lds
    v_exp_f32 v41, v41
    v_mfma_f32_16x16x32_bf16 v[76:79], v[148:151], v[220:223], v[76:79]
    ds_read_b64_tr_b16 a[214:215], v6 offset:672
    v_add_f32 v12, v12, v58
    v_mfma_f32_16x16x32_bf16 v[80:83], v[148:151], v[236:239], v[32:35]
    s_add_u32 m0, s34, 4000
    v_exp_f32 v42, v42
    v_mfma_f32_16x16x32_bf16 v[80:83], v[144:147], v[232:235], v[80:83]
    buffer_load_dwordx4 v156, s[20:23], s32 offen offset:1280 nt lds
    v_add_f32 v12, v12, v59
    v_mfma_f32_16x16x32_bf16 v[80:83], v[140:143], v[228:231], v[80:83]
    v_exp_f32 v43, v43
    v_mfma_f32_16x16x32_bf16 v[80:83], v[136:139], v[224:227], v[80:83]
    ds_read_b64_tr_b16 a[216:217], v6 offset:192
    ds_read_b64_tr_b16 a[218:219], v6 offset:704
    v_exp_f32 v44, v44
    v_exp_f32 v45, v45
    v_add_f32 v8, v8, v40
    v_mfma_f32_16x16x32_bf16 v[64:67], v[148:151], v[172:175], v[16:19]
    s_add_u32 m0, s34, 4800
    v_exp_f32 v46, v46
    v_add_u32 v5, s51, v3
    v_mfma_f32_16x16x32_bf16 v[64:67], v[144:147], v[168:171], v[64:67]
    buffer_load_dwordx4 v156, s[20:23], s32 offen offset:1536 nt lds
    v_add_f32 v8, v8, v41
    v_add_f32 v8, v8, v42
    v_mfma_f32_16x16x32_bf16 v[64:67], v[140:143], v[164:167], v[64:67]
    v_exp_f32 v47, v47
    v_mfma_f32_16x16x32_bf16 v[64:67], v[136:139], v[160:163], v[64:67]
    ds_read_b64_tr_b16 a[220:221], v6 offset:224
    v_add_f32 v8, v8, v43
    v_mfma_f32_16x16x32_bf16 v[68:71], v[136:139], v[176:179], v[20:23]
    s_add_u32 m0, s34, 5600
    v_exp_f32 v48, v48
    v_mfma_f32_16x16x32_bf16 v[68:71], v[140:143], v[180:183], v[68:71]
    buffer_load_dwordx4 v156, s[20:23], s32 offen offset:1792 nt lds
    v_add_f32 v9, v9, v44
    v_add_f32 v9, v9, v45
    v_mfma_f32_16x16x32_bf16 v[68:71], v[144:147], v[184:187], v[68:71]
    v_exp_f32 v49, v49
    v_mfma_f32_16x16x32_bf16 v[68:71], v[148:151], v[188:191], v[68:71]
    ds_read_b64_tr_b16 a[222:223], v6 offset:736
    v_add_f32 v9, v9, v46
    v_mfma_f32_16x16x32_bf16 v[72:75], v[148:151], v[204:207], v[24:27]
    s_waitcnt vmcnt(32)
    v_exp_f32 v50, v50
    v_mfma_f32_16x16x32_bf16 v[72:75], v[144:147], v[200:203], v[72:75]
    s_barrier
    v_add_f32 v9, v9, v47
    v_add_f32 v10, v10, v48
    v_mfma_f32_16x16x32_bf16 v[72:75], v[140:143], v[196:199], v[72:75]
    s_waitcnt lgkmcnt(6)
    v_exp_f32 v51, v51
    v_mfma_f32_16x16x32_bf16 v[72:75], v[136:139], v[192:195], v[72:75]
    ds_read_b128 v[148:151], v5 offset:192
    v_add_f32 v10, v10, v49
    v_mfma_f32_16x16x32_bf16 a[16:19], a[240:243], v[112:115], a[16:19]
    s_mov_b32 s33, s32
    v_exp_f32 v76, v76
    v_mfma_f32_16x16x32_bf16 a[16:19], a[208:211], v[88:91], a[16:19]
    s_add_u32 s38, s38, 8192
    v_add_f32 v10, v10, v50
    v_add_f32 v10, v10, v51
    v_mfma_f32_16x16x32_bf16 a[48:51], a[208:211], v[92:95], a[48:51]
    s_add_u32 s32, s38, s3
    v_exp_f32 v77, v77
    v_mfma_f32_16x16x32_bf16 a[48:51], a[240:243], v[116:119], a[48:51]
    ds_read_b128 v[144:147], v5 offset:128
    v_add_f32 v11, v11, v76
    v_mfma_f32_16x16x32_bf16 a[80:83], a[240:243], v[120:123], a[80:83]
    s_and_b32 s32, s32, 0x3ffff
    v_exp_f32 v78, v78
    v_mfma_f32_16x16x32_bf16 a[80:83], a[208:211], v[96:99], a[80:83]
    s_waitcnt lgkmcnt(6)
    v_cvt_pk_bf16_f32 v126, v76, v77
    v_add_f32 v11, v11, v77
    v_mfma_f32_16x16x32_bf16 a[84:87], a[212:215], v[96:99], a[84:87]
    s_and_b32 s39, s38, 0x40000
    v_exp_f32 v79, v79
    v_mfma_f32_16x16x32_bf16 a[84:87], a[244:247], v[120:123], a[84:87]
    ds_read_b128 v[140:143], v5 offset:64
    v_add_f32 v11, v11, v78
    v_mfma_f32_16x16x32_bf16 a[52:55], a[244:247], v[116:119], a[52:55]
    s_or_b32 s32, s32, s39
    v_exp_f32 v80, v80
    v_mfma_f32_16x16x32_bf16 a[52:55], a[212:215], v[92:95], a[52:55]
    s_add_u32 s35, s35, 8448
    v_cvt_pk_bf16_f32 v127, v78, v79
    v_add_f32 v11, v11, v79
    v_mfma_f32_16x16x32_bf16 a[20:23], a[212:215], v[88:91], a[20:23]
    s_waitcnt lgkmcnt(5)
    v_exp_f32 v81, v81
    v_mfma_f32_16x16x32_bf16 a[20:23], a[244:247], v[112:115], a[20:23]
    ds_read_b128 v[136:139], v5 offset:0
    v_add_f32 v12, v12, v80
    v_mfma_f32_16x16x32_bf16 a[24:27], a[248:251], v[112:115], a[24:27]
    s_cmp_eq_u32 s35, 101376
    v_exp_f32 v82, v82
    v_mfma_f32_16x16x32_bf16 a[24:27], a[216:219], v[88:91], a[24:27]
    s_cselect_b32 s35, 50688, s35
    v_cvt_pk_bf16_f32 v130, v80, v81
    v_add_f32 v12, v12, v81
    v_mfma_f32_16x16x32_bf16 a[56:59], a[216:219], v[92:95], a[56:59]
    s_add_u32 s34, s34, 8448
    v_exp_f32 v83, v83
    v_mfma_f32_16x16x32_bf16 a[56:59], a[248:251], v[116:119], a[56:59]
    ds_read_b64_tr_b16 a[224:225], v6 offset:8448
    v_add_f32 v12, v12, v82
    v_mfma_f32_16x16x32_bf16 a[88:91], a[248:251], v[120:123], a[88:91]
    s_cmp_eq_u32 s34, 50688
    v_mfma_f32_16x16x32_bf16 a[88:91], a[216:219], v[96:99], a[88:91]
    s_waitcnt lgkmcnt(5)
    v_cvt_pk_bf16_f32 v131, v82, v83
    v_add_f32 v12, v12, v83
    v_mfma_f32_16x16x32_bf16 a[92:95], a[220:223], v[96:99], a[92:95]
    s_cselect_b32 s34, 0, s34
    v_mfma_f32_16x16x32_bf16 a[92:95], a[252:255], v[120:123], a[92:95]
    ds_read_b64_tr_b16 a[226:227], v6 offset:8960
    v_mfma_f32_16x16x32_bf16 a[60:63], a[252:255], v[116:119], a[60:63]
    v_mfma_f32_16x16x32_bf16 a[60:63], a[220:223], v[92:95], a[60:63]
    v_mfma_f32_16x16x32_bf16 a[28:31], a[220:223], v[88:91], a[28:31]
    s_waitcnt lgkmcnt(2)
    v_mfma_f32_16x16x32_bf16 a[28:31], a[252:255], v[112:115], a[28:31]
    ds_read_b64_tr_b16 a[228:229], v6 offset:8480
    v_mfma_f32_16x16x32_bf16 v[52:55], v[136:139], v[208:211], v[28:31]
L_lloop_mid:
    v_exp_f32 v64, v64
    v_mfma_f32_16x16x32_bf16 v[52:55], v[140:143], v[212:215], v[52:55]
    s_add_u32 m0, s35, 0
    v_cvt_pk_bf16_f32 v112, v40, v41
    v_cvt_pk_bf16_f32 v113, v42, v43
    v_mfma_f32_16x16x32_bf16 v[52:55], v[144:147], v[216:219], v[52:55]
    buffer_load_dwordx4 v156, s[24:27], s33 offen offset:0 nt lds
    v_exp_f32 v65, v65
    v_mfma_f32_16x16x32_bf16 v[52:55], v[148:151], v[220:223], v[52:55]
    ds_read_b64_tr_b16 a[230:231], v6 offset:8992
    v_cvt_pk_bf16_f32 v116, v44, v45
    v_mfma_f32_16x16x32_bf16 v[56:59], v[148:151], v[236:239], v[32:35]
    s_add_u32 m0, s35, 800
    v_exp_f32 v66, v66
    v_mfma_f32_16x16x32_bf16 v[56:59], v[144:147], v[232:235], v[56:59]
    buffer_load_dwordx4 v156, s[24:27], s33 offen offset:256 nt lds
    v_cvt_pk_bf16_f32 v117, v46, v47
    v_cvt_pk_bf16_f32 v120, v48, v49
    v_mfma_f32_16x16x32_bf16 v[56:59], v[140:143], v[228:231], v[56:59]
    v_exp_f32 v67, v67
    v_mfma_f32_16x16x32_bf16 v[56:59], v[136:139], v[224:227], v[56:59]
    ds_read_b64_tr_b16 a[232:233], v6 offset:8512
    ds_read_b64_tr_b16 a[234:235], v6 offset:9024
    v_cvt_pk_bf16_f32 v121, v50, v51
    v_exp_f32 v68, v68
    v_cvt_pk_bf16_f32 v114, v64, v65
    v_exp_f32 v69, v69
    v_cvt_pk_bf16_f32 v115, v66, v67
    v_mfma_f32_16x16x32_bf16 v[40:43], v[148:151], v[172:175], v[16:19]
    s_add_u32 m0, s35, 1600
    v_exp_f32 v70, v70
    v_mfma_f32_16x16x32_bf16 v[40:43], v[144:147], v[168:171], v[40:43]
    buffer_load_dwordx4 v156, s[24:27], s33 offen offset:512 nt lds
    v_cvt_pk_bf16_f32 v118, v68, v69
    v_mfma_f32_16x16x32_bf16 v[40:43], v[140:143], v[164:167], v[40:43]
    s_add_u32 m0, s35, 2400
    v_exp_f32 v71, v71
    v_mfma_f32_16x16x32_bf16 v[40:43], v[136:139], v[160:163], v[40:43]
    ds_read_b64_tr_b16 a[236:237], v6 offset:8544
    v_add_f32 v8, v8, v64
    v_mfma_f32_16x16x32_bf16 v[44:47], v[136:139], v[176:179], v[20:23]
    buffer_load_dwordx4 v156, s[24:27], s33 offen offset:768 nt lds
    v_exp_f32 v72, v72
    v_mfma_f32_16x16x32_bf16 v[44:47], v[140:143], v[180:183], v[44:47]
    s_add_u32 m0, s35, 3200
    v_cvt_pk_bf16_f32 v119, v70, v71
    v_add_f32 v8, v8, v65
    v_mfma_f32_16x16x32_bf16 v[44:47], v[144:147], v[184:187], v[44:47]
    buffer_load_dwordx4 v156, s[24:27], s33 offen offset:1024 nt lds
    v_exp_f32 v73, v73
    v_mfma_f32_16x16x32_bf16 v[44:47], v[148:151], v[188:191], v[44:47]
    ds_read_b64_tr_b16 a[238:239], v6 offset:9056
    v_add_f32 v8, v8, v66
    v_mfma_f32_16x16x32_bf16 v[48:51], v[148:151], v[204:207], v[24:27]
    s_add_u32 m0, s35, 4000
    v_exp_f32 v74, v74
    v_mfma_f32_16x16x32_bf16 v[48:51], v[144:147], v[200:203], v[48:51]
    buffer_load_dwordx4 v156, s[24:27], s33 offen offset:1280 nt lds
    v_cvt_pk_bf16_f32 v122, v72, v73
    v_add_f32 v8, v8, v67
    v_mfma_f32_16x16x32_bf16 v[48:51], v[140:143], v[196:199], v[48:51]
    s_waitcnt lgkmcnt(6)
    v_exp_f32 v75, v75
    v_mfma_f32_16x16x32_bf16 v[48:51], v[136:139], v[192:195], v[48:51]
    ds_read_b128 v[148:151], v5 offset:704
    v_add_f32 v9, v9, v68
    v_mfma_f32_16x16x32_bf16 a[96:99], a[192:195], v[100:103], a[96:99]
    s_add_u32 m0, s35, 4800
    v_exp_f32 v40, v40
    v_mfma_f32_16x16x32_bf16 a[96:99], a[224:227], v[124:127], a[96:99]
    buffer_load_dwordx4 v156, s[24:27], s33 offen offset:1536 nt lds
    v_cvt_pk_bf16_f32 v123, v74, v75
    v_add_f32 v9, v9, v69
    v_mfma_f32_16x16x32_bf16 a[128:131], a[224:227], v[128:131], a[128:131]
    s_waitcnt lgkmcnt(5)
    v_exp_f32 v41, v41
    v_mfma_f32_16x16x32_bf16 a[128:131], a[192:195], v[104:107], a[128:131]
    ds_read_b128 v[144:147], v5 offset:640
    ds_read_b128 v[140:143], v5 offset:576
    s_add_u32 m0, s35, 5600
    v_add_f32 v9, v9, v70
    v_exp_f32 v42, v42
    v_add_f32 v9, v9, v71
    v_cvt_pk_bf16_f32 v88, v40, v41
    v_exp_f32 v43, v43
    v_add_f32 v10, v10, v72
    v_mfma_f32_16x16x32_bf16 a[132:135], a[196:199], v[104:107], a[132:135]
    buffer_load_dwordx4 v156, s[24:27], s33 offen offset:1792 nt lds
    v_exp_f32 v44, v44
    v_mfma_f32_16x16x32_bf16 a[132:135], a[228:231], v[128:131], a[132:135]
    v_add_f32 v10, v10, v73
    v_cvt_pk_bf16_f32 v89, v42, v43
    v_mfma_f32_16x16x32_bf16 a[100:103], a[228:231], v[124:127], a[100:103]
    s_waitcnt lgkmcnt(5)
    s_add_u32 m0, s34, 0
    v_exp_f32 v45, v45
    v_mfma_f32_16x16x32_bf16 a[100:103], a[196:199], v[100:103], a[100:103]
    ds_read_b128 v[136:139], v5 offset:512
    v_add_f32 v10, v10, v74
    v_mfma_f32_16x16x32_bf16 a[104:107], a[200:203], v[100:103], a[104:107]
    buffer_load_dwordx4 v156, s[20:23], s32 offen offset:0 nt lds
    v_exp_f32 v46, v46
    v_mfma_f32_16x16x32_bf16 a[104:107], a[232:235], v[124:127], a[104:107]
    s_add_u32 m0, s34, 800
    v_add_f32 v10, v10, v75
    v_cvt_pk_bf16_f32 v92, v44, v45
    v_mfma_f32_16x16x32_bf16 a[136:139], a[232:235], v[128:131], a[136:139]
    buffer_load_dwordx4 v156, s[20:23], s32 offen offset:256 nt lds
    s_waitcnt lgkmcnt(4)
    v_exp_f32 v47, v47
    v_mfma_f32_16x16x32_bf16 a[136:139], a[200:203], v[104:107], a[136:139]
    ds_read_b64_tr_b16 a[240:241], v6 offset:8576
    ds_read_b64_tr_b16 a[242:243], v6 offset:9088
    v_add_f32 v8, v8, v40
    v_exp_f32 v48, v48
    v_cvt_pk_bf16_f32 v93, v46, v47
    v_add_f32 v8, v8, v41
    v_exp_f32 v49, v49
    v_add_f32 v8, v8, v42
    v_mfma_f32_16x16x32_bf16 a[140:143], a[204:207], v[104:107], a[140:143]
    s_add_u32 m0, s34, 1600
    v_exp_f32 v50, v50
    v_mfma_f32_16x16x32_bf16 a[140:143], a[236:239], v[128:131], a[140:143]
    buffer_load_dwordx4 v156, s[20:23], s32 offen offset:512 nt lds
    v_cvt_pk_bf16_f32 v96, v48, v49
    v_add_f32 v8, v8, v43
    v_mfma_f32_16x16x32_bf16 a[108:111], a[236:239], v[124:127], a[108:111]
    s_waitcnt lgkmcnt(2)
    v_exp_f32 v51, v51
    v_mfma_f32_16x16x32_bf16 a[108:111], a[204:207], v[100:103], a[108:111]
    ds_read_b64_tr_b16 a[244:245], v6 offset:8608
    v_add_f32 v9, v9, v44
    v_mfma_f32_16x16x32_bf16 v[64:67], v[136:139], v[160:163], v[16:19]
    s_add_u32 m0, s34, 2400
    v_exp_f32 v52, v52
    v_mfma_f32_16x16x32_bf16 v[64:67], v[140:143], v[164:167], v[64:67]
    buffer_load_dwordx4 v156, s[20:23], s32 offen offset:768 nt lds
    v_cvt_pk_bf16_f32 v97, v50, v51
    v_add_f32 v9, v9, v45
    v_mfma_f32_16x16x32_bf16 v[64:67], v[144:147], v[168:171], v[64:67]
    v_exp_f32 v53, v53
    v_mfma_f32_16x16x32_bf16 v[64:67], v[148:151], v[172:175], v[64:67]
    ds_read_b64_tr_b16 a[246:247], v6 offset:9120
    s_add_u32 m0, s34, 3200
    v_add_f32 v9, v9, v46
    v_mfma_f32_16x16x32_bf16 v[68:71], v[148:151], v[188:191], v[20:23]
    buffer_load_dwordx4 v156, s[20:23], s32 offen offset:1024 nt lds
    v_exp_f32 v54, v54
    v_mfma_f32_16x16x32_bf16 v[68:71], v[144:147], v[184:187], v[68:71]
    v_add_f32 v9, v9, v47
    v_add_f32 v10, v10, v48
    v_mfma_f32_16x16x32_bf16 v[68:71], v[140:143], v[180:183], v[68:71]
    s_add_u32 m0, s34, 4000
    v_exp_f32 v55, v55
    v_mfma_f32_16x16x32_bf16 v[68:71], v[136:139], v[176:179], v[68:71]
    ds_read_b64_tr_b16 a[248:249], v6 offset:8640
    v_add_f32 v10, v10, v49
    v_mfma_f32_16x16x32_bf16 v[72:75], v[136:139], v[192:195], v[24:27]
    buffer_load_dwordx4 v156, s[20:23], s32 offen offset:1280 nt lds
    v_exp_f32 v56, v56
    v_mfma_f32_16x16x32_bf16 v[72:75], v[140:143], v[196:199], v[72:75]
    s_add_u32 m0, s34, 4800
    v_add_f32 v10, v10, v50
    v_add_f32 v10, v10, v51
    v_mfma_f32_16x16x32_bf16 v[72:75], v[144:147], v[200:203], v[72:75]
    buffer_load_dwordx4 v156, s[20:23], s32 offen offset:1536 nt lds
    v_exp_f32 v57, v57
    v_mfma_f32_16x16x32_bf16 v[72:75], v[148:151], v[204:207], v[72:75]
    ds_read_b64_tr_b16 a[250:251], v6 offset:9152
    v_add_f32 v11, v11, v52
    v_mfma_f32_16x16x32_bf16 v[76:79], v[148:151], v[220:223], v[28:31]
    s_add_u32 m0, s34, 5600
    v_exp_f32 v58, v58
    v_mfma_f32_16x16x32_bf16 v[76:79], v[144:147], v[216:219], v[76:79]
    buffer_load_dwordx4 v156, s[20:23], s32 offen offset:1792 nt lds
    v_add_f32 v11, v11, v53
    v_add_f32 v11, v11, v54
    v_mfma_f32_16x16x32_bf16 v[76:79], v[140:143], v[212:215], v[76:79]
    v_exp_f32 v59, v59
    v_mfma_f32_16x16x32_bf16 v[76:79], v[136:139], v[208:211], v[76:79]
    ds_read_b64_tr_b16 a[252:253], v6 offset:8672
    v_add_f32 v11, v11, v55
    v_mfma_f32_16x16x32_bf16 v[80:83], v[136:139], v[224:227], v[32:35]
    s_waitcnt vmcnt(32)
    v_mfma_f32_16x16x32_bf16 v[80:83], v[140:143], v[228:231], v[80:83]
    s_barrier
    v_add_f32 v12, v12, v56
    v_add_f32 v12, v12, v57
    v_mfma_f32_16x16x32_bf16 v[80:83], v[144:147], v[232:235], v[80:83]
    s_waitcnt lgkmcnt(5)
    v_mfma_f32_16x16x32_bf16 v[80:83], v[148:151], v[236:239], v[80:83]
    ds_read_b64_tr_b16 a[254:255], v6 offset:9184
    ds_read_b128 v[148:151], v5 offset:8640
    v_add_f32 v12, v12, v58
    v_add_u32 v6, s51, v4
    v_add_f32 v12, v12, v59
    v_mfma_f32_16x16x32_bf16 a[112:115], a[208:211], v[100:103], a[112:115]
    s_mov_b32 s33, s32
    s_add_u32 s38, s38, 8192
    v_exp_f32 v64, v64
    v_mfma_f32_16x16x32_bf16 a[112:115], a[240:243], v[124:127], a[112:115]
    s_add_u32 s32, s38, s3
    v_mfma_f32_16x16x32_bf16 a[144:147], a[240:243], v[128:131], a[144:147]
    s_waitcnt lgkmcnt(5)
    s_and_b32 s32, s32, 0x3ffff
    v_exp_f32 v65, v65
    v_mfma_f32_16x16x32_bf16 a[144:147], a[208:211], v[104:107], a[144:147]
    ds_read_b128 v[144:147], v5 offset:8576
    ds_read_b128 v[140:143], v5 offset:8512
    s_and_b32 s39, s38, 0x40000
    v_add_f32 v8, v8, v64
    v_exp_f32 v66, v66
    v_cvt_pk_bf16_f32 v90, v64, v65
    v_add_f32 v8, v8, v65
    v_exp_f32 v67, v67
    v_add_f32 v8, v8, v66
    v_mfma_f32_16x16x32_bf16 a[148:151], a[212:215], v[104:107], a[148:151]
    s_or_b32 s32, s32, s39
    v_exp_f32 v68, v68
    v_mfma_f32_16x16x32_bf16 a[148:151], a[244:247], v[128:131], a[148:151]
    s_add_u32 s35, s35, 8448
    v_cvt_pk_bf16_f32 v91, v66, v67
    v_add_f32 v8, v8, v67
    v_mfma_f32_16x16x32_bf16 a[116:119], a[244:247], v[124:127], a[116:119]
    s_waitcnt lgkmcnt(5)
    s_cmp_eq_u32 s35, 101376
    v_exp_f32 v69, v69
    v_mfma_f32_16x16x32_bf16 a[116:119], a[212:215], v[100:103], a[116:119]
    ds_read_b128 v[136:139], v5 offset:8448
    s_cselect_b32 s35, 50688, s35
    v_add_f32 v9, v9, v68
    v_mfma_f32_16x16x32_bf16 a[120:123], a[216:219], v[100:103], a[120:123]
    s_add_u32 s34, s34, 8448
    v_exp_f32 v70, v70
    v_mfma_f32_16x16x32_bf16 a[120:123], a[248:251], v[124:127], a[120:123]
    s_cmp_eq_u32 s34, 50688
    v_cvt_pk_bf16_f32 v94, v68, v69
    v_add_f32 v9, v9, v69
    v_mfma_f32_16x16x32_bf16 a[152:155], a[248:251], v[128:131], a[152:155]
    s_waitcnt lgkmcnt(4)
    s_cselect_b32 s34, 0, s34
    v_exp_f32 v71, v71
    v_mfma_f32_16x16x32_bf16 a[152:155], a[216:219], v[104:107], a[152:155]
    ds_read_b64_tr_b16 a[192:193], v6 offset:0
    ds_read_b64_tr_b16 a[194:195], v6 offset:512
    s_add_u32 s51, s51, 16896
    v_add_f32 v9, v9, v70
    v_exp_f32 v72, v72
    v_cvt_pk_bf16_f32 v95, v70, v71
    v_add_f32 v9, v9, v71
    v_exp_f32 v73, v73
    v_add_f32 v10, v10, v72
    v_mfma_f32_16x16x32_bf16 a[156:159], a[220:223], v[104:107], a[156:159]
    s_cmp_eq_u32 s51, 50688
    v_exp_f32 v74, v74
    v_mfma_f32_16x16x32_bf16 a[156:159], a[252:255], v[128:131], a[156:159]
    s_cselect_b32 s51, 0, s51
    v_cvt_pk_bf16_f32 v98, v72, v73
    v_add_f32 v10, v10, v73
    v_mfma_f32_16x16x32_bf16 a[124:127], a[252:255], v[124:127], a[124:127]
    s_waitcnt lgkmcnt(2)
    s_sub_u32 s52, s52, 1
    v_exp_f32 v75, v75
    v_mfma_f32_16x16x32_bf16 a[124:127], a[220:223], v[100:103], a[124:127]
    ds_read_b64_tr_b16 a[196:197], v6 offset:32
    s_cmp_lg_u32 s52, 0
    v_add_f32 v10, v10, v74
    v_mfma_f32_16x16x32_bf16 v[40:43], v[136:139], v[160:163], v[16:19]
    s_cbranch_scc1 L_lloop
    s_branch L_tail
L_lend:
L_fallback:
    s_mov_b32 s50, 1
    s_waitcnt vmcnt(0)
    v_mbcnt_lo_u32_b32 v14, -1, 0
    v_mbcnt_hi_u32_b32 v14, -1, v14
    v_and_b32 v15, 15, v14
    v_lshrrev_b32 v14, 4, v14
    v_lshlrev_b32 v15, 8, v15
    v_lshl_add_u32 v15, v14, 4, v15
    s_mul_i32 s42, s49, 24576
    v_add_u32 v15, s42, v15
    buffer_load_dwordx4 v[160:163], v15, s[16:19], s53 offen offset:0
    buffer_load_dwordx4 v[164:167], v15, s[16:19], s53 offen offset:64
    buffer_load_dwordx4 v[168:171], v15, s[16:19], s53 offen offset:128
    buffer_load_dwordx4 v[172:175], v15, s[16:19], s53 offen offset:192
    buffer_load_dwordx4 v[176:179], v15, s[16:19], s54 offen offset:0
    buffer_load_dwordx4 v[180:183], v15, s[16:19], s54 offen offset:64
    buffer_load_dwordx4 v[184:187], v15, s[16:19], s54 offen offset:128
    buffer_load_dwordx4 v[188:191], v15, s[16:19], s54 offen offset:192
    buffer_load_dwordx4 v[192:195], v15, s[16:19], s55 offen offset:0
    buffer_load_dwordx4 v[196:199], v15, s[16:19], s55 offen offset:64
    buffer_load_dwordx4 v[200:203], v15, s[16:19], s55 offen offset:128
    buffer_load_dwordx4 v[204:207], v15, s[16:19], s55 offen offset:192
    buffer_load_dwordx4 v[208:211], v15, s[16:19], s56 offen offset:0
    buffer_load_dwordx4 v[212:215], v15, s[16:19], s56 offen offset:64
    buffer_load_dwordx4 v[216:219], v15, s[16:19], s56 offen offset:128
    buffer_load_dwordx4 v[220:223], v15, s[16:19], s56 offen offset:192
    buffer_load_dwordx4 v[224:227], v15, s[16:19], s57 offen offset:0
    buffer_load_dwordx4 v[228:231], v15, s[16:19], s57 offen offset:64
    buffer_load_dwordx4 v[232:235], v15, s[16:19], s57 offen offset:128
    buffer_load_dwordx4 v[236:239], v15, s[16:19], s57 offen offset:192
    buffer_load_dwordx4 v[240:243], v15, s[16:19], s58 offen offset:0
    buffer_load_dwordx4 v[244:247], v15, s[16:19], s58 offen offset:64
    buffer_load_dwordx4 v[248:251], v15, s[16:19], s58 offen offset:128
    buffer_load_dwordx4 v[252:255], v15, s[16:19], s58 offen offset:192
    s_waitcnt vmcnt(0)
    v_lshlrev_b32 v112, 16, v160
    v_and_b32 v113, s48, v160
    v_lshlrev_b32 v114, 16, v161
    v_and_b32 v115, s48, v161
    v_lshlrev_b32 v116, 16, v162
    v_and_b32 v117, s48, v162
    v_lshlrev_b32 v118, 16, v163
    v_and_b32 v119, s48, v163
    v_pk_mul_f32 v[112:113], v[112:113], s[40:41]
    v_pk_mul_f32 v[114:115], v[114:115], s[40:41]
    v_pk_mul_f32 v[116:117], v[116:117], s[40:41]
    v_pk_mul_f32 v[118:119], v[118:119], s[40:41]
    v_cvt_pk_bf16_f32 v160, v112, v113
    v_cvt_pk_bf16_f32 v161, v114, v115
    v_cvt_pk_bf16_f32 v162, v116, v117
    v_cvt_pk_bf16_f32 v163, v118, v119
    v_lshlrev_b32 v112, 16, v164
    v_and_b32 v113, s48, v164
    v_lshlrev_b32 v114, 16, v165
    v_and_b32 v115, s48, v165
    v_lshlrev_b32 v116, 16, v166
    v_and_b32 v117, s48, v166
    v_lshlrev_b32 v118, 16, v167
    v_and_b32 v119, s48, v167
    v_pk_mul_f32 v[112:113], v[112:113], s[40:41]
    v_pk_mul_f32 v[114:115], v[114:115], s[40:41]
    v_pk_mul_f32 v[116:117], v[116:117], s[40:41]
    v_pk_mul_f32 v[118:119], v[118:119], s[40:41]
    v_cvt_pk_bf16_f32 v164, v112, v113
    v_cvt_pk_bf16_f32 v165, v114, v115
    v_cvt_pk_bf16_f32 v166, v116, v117
    v_cvt_pk_bf16_f32 v167, v118, v119
    v_lshlrev_b32 v112, 16, v168
    v_and_b32 v113, s48, v168
    v_lshlrev_b32 v114, 16, v169
    v_and_b32 v115, s48, v169
    v_lshlrev_b32 v116, 16, v170
    v_and_b32 v117, s48, v170
    v_lshlrev_b32 v118, 16, v171
    v_and_b32 v119, s48, v171
    v_pk_mul_f32 v[112:113], v[112:113], s[40:41]
    v_pk_mul_f32 v[114:115], v[114:115], s[40:41]
    v_pk_mul_f32 v[116:117], v[116:117], s[40:41]
    v_pk_mul_f32 v[118:119], v[118:119], s[40:41]
    v_cvt_pk_bf16_f32 v168, v112, v113
    v_cvt_pk_bf16_f32 v169, v114, v115
    v_cvt_pk_bf16_f32 v170, v116, v117
    v_cvt_pk_bf16_f32 v171, v118, v119
    v_lshlrev_b32 v112, 16, v172
    v_and_b32 v113, s48, v172
    v_lshlrev_b32 v114, 16, v173
    v_and_b32 v115, s48, v173
    v_lshlrev_b32 v116, 16, v174
    v_and_b32 v117, s48, v174
    v_lshlrev_b32 v118, 16, v175
    v_and_b32 v119, s48, v175
    v_pk_mul_f32 v[112:113], v[112:113], s[40:41]
    v_pk_mul_f32 v[114:115], v[114:115], s[40:41]
    v_pk_mul_f32 v[116:117], v[116:117], s[40:41]
    v_pk_mul_f32 v[118:119], v[118:119], s[40:41]
    v_cvt_pk_bf16_f32 v172, v112, v113
    v_cvt_pk_bf16_f32 v173, v114, v115
    v_cvt_pk_bf16_f32 v174, v116, v117
    v_cvt_pk_bf16_f32 v175, v118, v119
    v_lshlrev_b32 v112, 16, v176
    v_and_b32 v113, s48, v176
    v_lshlrev_b32 v114, 16, v177
    v_and_b32 v115, s48, v177
    v_lshlrev_b32 v116, 16, v178
    v_and_b32 v117, s48, v178
    v_lshlrev_b32 v118, 16, v179
    v_and_b32 v119, s48, v179
    v_pk_mul_f32 v[112:113], v[112:113], s[40:41]
    v_pk_mul_f32 v[114:115], v[114:115], s[40:41]
    v_pk_mul_f32 v[116:117], v[116:117], s[40:41]
    v_pk_mul_f32 v[118:119], v[118:119], s[40:41]
    v_cvt_pk_bf16_f32 v176, v112, v113
    v_cvt_pk_bf16_f32 v177, v114, v115
    v_cvt_pk_bf16_f32 v178, v116, v117
    v_cvt_pk_bf16_f32 v179, v118, v119
    v_lshlrev_b32 v112, 16, v180
    v_and_b32 v113, s48, v180
    v_lshlrev_b32 v114, 16, v181
    v_and_b32 v115, s48, v181
    v_lshlrev_b32 v116, 16, v182
    v_and_b32 v117, s48, v182
    v_lshlrev_b32 v118, 16, v183
    v_and_b32 v119, s48, v183
    v_pk_mul_f32 v[112:113], v[112:113], s[40:41]
    v_pk_mul_f32 v[114:115], v[114:115], s[40:41]
    v_pk_mul_f32 v[116:117], v[116:117], s[40:41]
    v_pk_mul_f32 v[118:119], v[118:119], s[40:41]
    v_cvt_pk_bf16_f32 v180, v112, v113
    v_cvt_pk_bf16_f32 v181, v114, v115
    v_cvt_pk_bf16_f32 v182, v116, v117
    v_cvt_pk_bf16_f32 v183, v118, v119
    v_lshlrev_b32 v112, 16, v184
    v_and_b32 v113, s48, v184
    v_lshlrev_b32 v114, 16, v185
    v_and_b32 v115, s48, v185
    v_lshlrev_b32 v116, 16, v186
    v_and_b32 v117, s48, v186
    v_lshlrev_b32 v118, 16, v187
    v_and_b32 v119, s48, v187
    v_pk_mul_f32 v[112:113], v[112:113], s[40:41]
    v_pk_mul_f32 v[114:115], v[114:115], s[40:41]
    v_pk_mul_f32 v[116:117], v[116:117], s[40:41]
    v_pk_mul_f32 v[118:119], v[118:119], s[40:41]
    v_cvt_pk_bf16_f32 v184, v112, v113
    v_cvt_pk_bf16_f32 v185, v114, v115
    v_cvt_pk_bf16_f32 v186, v116, v117
    v_cvt_pk_bf16_f32 v187, v118, v119
    v_lshlrev_b32 v112, 16, v188
    v_and_b32 v113, s48, v188
    v_lshlrev_b32 v114, 16, v189
    v_and_b32 v115, s48, v189
    v_lshlrev_b32 v116, 16, v190
    v_and_b32 v117, s48, v190
    v_lshlrev_b32 v118, 16, v191
    v_and_b32 v119, s48, v191
    v_pk_mul_f32 v[112:113], v[112:113], s[40:41]
    v_pk_mul_f32 v[114:115], v[114:115], s[40:41]
    v_pk_mul_f32 v[116:117], v[116:117], s[40:41]
    v_pk_mul_f32 v[118:119], v[118:119], s[40:41]
    v_cvt_pk_bf16_f32 v188, v112, v113
    v_cvt_pk_bf16_f32 v189, v114, v115
    v_cvt_pk_bf16_f32 v190, v116, v117
    v_cvt_pk_bf16_f32 v191, v118, v119
    v_lshlrev_b32 v112, 16, v192
    v_and_b32 v113, s48, v192
    v_lshlrev_b32 v114, 16, v193
    v_and_b32 v115, s48, v193
    v_lshlrev_b32 v116, 16, v194
    v_and_b32 v117, s48, v194
    v_lshlrev_b32 v118, 16, v195
    v_and_b32 v119, s48, v195
    v_pk_mul_f32 v[112:113], v[112:113], s[40:41]
    v_pk_mul_f32 v[114:115], v[114:115], s[40:41]
    v_pk_mul_f32 v[116:117], v[116:117], s[40:41]
    v_pk_mul_f32 v[118:119], v[118:119], s[40:41]
    v_cvt_pk_bf16_f32 v192, v112, v113
    v_cvt_pk_bf16_f32 v193, v114, v115
    v_cvt_pk_bf16_f32 v194, v116, v117
    v_cvt_pk_bf16_f32 v195, v118, v119
    v_lshlrev_b32 v112, 16, v196
    v_and_b32 v113, s48, v196
    v_lshlrev_b32 v114, 16, v197
    v_and_b32 v115, s48, v197
    v_lshlrev_b32 v116, 16, v198
    v_and_b32 v117, s48, v198
    v_lshlrev_b32 v118, 16, v199
    v_and_b32 v119, s48, v199
    v_pk_mul_f32 v[112:113], v[112:113], s[40:41]
    v_pk_mul_f32 v[114:115], v[114:115], s[40:41]
    v_pk_mul_f32 v[116:117], v[116:117], s[40:41]
    v_pk_mul_f32 v[118:119], v[118:119], s[40:41]
    v_cvt_pk_bf16_f32 v196, v112, v113
    v_cvt_pk_bf16_f32 v197, v114, v115
    v_cvt_pk_bf16_f32 v198, v116, v117
    v_cvt_pk_bf16_f32 v199, v118, v119
    v_lshlrev_b32 v112, 16, v200
    v_and_b32 v113, s48, v200
    v_lshlrev_b32 v114, 16, v201
    v_and_b32 v115, s48, v201
    v_lshlrev_b32 v116, 16, v202
    v_and_b32 v117, s48, v202
    v_lshlrev_b32 v118, 16, v203
    v_and_b32 v119, s48, v203
    v_pk_mul_f32 v[112:113], v[112:113], s[40:41]
    v_pk_mul_f32 v[114:115], v[114:115], s[40:41]
    v_pk_mul_f32 v[116:117], v[116:117], s[40:41]
    v_pk_mul_f32 v[118:119], v[118:119], s[40:41]
    v_cvt_pk_bf16_f32 v200, v112, v113
    v_cvt_pk_bf16_f32 v201, v114, v115
    v_cvt_pk_bf16_f32 v202, v116, v117
    v_cvt_pk_bf16_f32 v203, v118, v119
    v_lshlrev_b32 v112, 16, v204
    v_and_b32 v113, s48, v204
    v_lshlrev_b32 v114, 16, v205
    v_and_b32 v115, s48, v205
    v_lshlrev_b32 v116, 16, v206
    v_and_b32 v117, s48, v206
    v_lshlrev_b32 v118, 16, v207
    v_and_b32 v119, s48, v207
    v_pk_mul_f32 v[112:113], v[112:113], s[40:41]
    v_pk_mul_f32 v[114:115], v[114:115], s[40:41]
    v_pk_mul_f32 v[116:117], v[116:117], s[40:41]
    v_pk_mul_f32 v[118:119], v[118:119], s[40:41]
    v_cvt_pk_bf16_f32 v204, v112, v113
    v_cvt_pk_bf16_f32 v205, v114, v115
    v_cvt_pk_bf16_f32 v206, v116, v117
    v_cvt_pk_bf16_f32 v207, v118, v119
    v_lshlrev_b32 v112, 16, v208
    v_and_b32 v113, s48, v208
    v_lshlrev_b32 v114, 16, v209
    v_and_b32 v115, s48, v209
    v_lshlrev_b32 v116, 16, v210
    v_and_b32 v117, s48, v210
    v_lshlrev_b32 v118, 16, v211
    v_and_b32 v119, s48, v211
    v_pk_mul_f32 v[112:113], v[112:113], s[40:41]
    v_pk_mul_f32 v[114:115], v[114:115], s[40:41]
    v_pk_mul_f32 v[116:117], v[116:117], s[40:41]
    v_pk_mul_f32 v[118:119], v[118:119], s[40:41]
    v_cvt_pk_bf16_f32 v208, v112, v113
    v_cvt_pk_bf16_f32 v209, v114, v115
    v_cvt_pk_bf16_f32 v210, v116, v117
    v_cvt_pk_bf16_f32 v211, v118, v119
    v_lshlrev_b32 v112, 16, v212
    v_and_b32 v113, s48, v212
    v_lshlrev_b32 v114, 16, v213
    v_and_b32 v115, s48, v213
    v_lshlrev_b32 v116, 16, v214
    v_and_b32 v117, s48, v214
    v_lshlrev_b32 v118, 16, v215
    v_and_b32 v119, s48, v215
    v_pk_mul_f32 v[112:113], v[112:113], s[40:41]
    v_pk_mul_f32 v[114:115], v[114:115], s[40:41]
    v_pk_mul_f32 v[116:117], v[116:117], s[40:41]
    v_pk_mul_f32 v[118:119], v[118:119], s[40:41]
    v_cvt_pk_bf16_f32 v212, v112, v113
    v_cvt_pk_bf16_f32 v213, v114, v115
    v_cvt_pk_bf16_f32 v214, v116, v117
    v_cvt_pk_bf16_f32 v215, v118, v119
    v_lshlrev_b32 v112, 16, v216
    v_and_b32 v113, s48, v216
    v_lshlrev_b32 v114, 16, v217
    v_and_b32 v115, s48, v217
    v_lshlrev_b32 v116, 16, v218
    v_and_b32 v117, s48, v218
    v_lshlrev_b32 v118, 16, v219
    v_and_b32 v119, s48, v219
    v_pk_mul_f32 v[112:113], v[112:113], s[40:41]
    v_pk_mul_f32 v[114:115], v[114:115], s[40:41]
    v_pk_mul_f32 v[116:117], v[116:117], s[40:41]
    v_pk_mul_f32 v[118:119], v[118:119], s[40:41]
    v_cvt_pk_bf16_f32 v216, v112, v113
    v_cvt_pk_bf16_f32 v217, v114, v115
    v_cvt_pk_bf16_f32 v218, v116, v117
    v_cvt_pk_bf16_f32 v219, v118, v119
    v_lshlrev_b32 v112, 16, v220
    v_and_b32 v113, s48, v220
    v_lshlrev_b32 v114, 16, v221
    v_and_b32 v115, s48, v221
    v_lshlrev_b32 v116, 16, v222
    v_and_b32 v117, s48, v222
    v_lshlrev_b32 v118, 16, v223
    v_and_b32 v119, s48, v223
    v_pk_mul_f32 v[112:113], v[112:113], s[40:41]
    v_pk_mul_f32 v[114:115], v[114:115], s[40:41]
    v_pk_mul_f32 v[116:117], v[116:117], s[40:41]
    v_pk_mul_f32 v[118:119], v[118:119], s[40:41]
    v_cvt_pk_bf16_f32 v220, v112, v113
    v_cvt_pk_bf16_f32 v221, v114, v115
    v_cvt_pk_bf16_f32 v222, v116, v117
    v_cvt_pk_bf16_f32 v223, v118, v119
    v_lshlrev_b32 v112, 16, v224
    v_and_b32 v113, s48, v224
    v_lshlrev_b32 v114, 16, v225
    v_and_b32 v115, s48, v225
    v_lshlrev_b32 v116, 16, v226
    v_and_b32 v117, s48, v226
    v_lshlrev_b32 v118, 16, v227
    v_and_b32 v119, s48, v227
    v_pk_mul_f32 v[112:113], v[112:113], s[40:41]
    v_pk_mul_f32 v[114:115], v[114:115], s[40:41]
    v_pk_mul_f32 v[116:117], v[116:117], s[40:41]
    v_pk_mul_f32 v[118:119], v[118:119], s[40:41]
    v_cvt_pk_bf16_f32 v224, v112, v113
    v_cvt_pk_bf16_f32 v225, v114, v115
    v_cvt_pk_bf16_f32 v226, v116, v117
    v_cvt_pk_bf16_f32 v227, v118, v119
    v_lshlrev_b32 v112, 16, v228
    v_and_b32 v113, s48, v228
    v_lshlrev_b32 v114, 16, v229
    v_and_b32 v115, s48, v229
    v_lshlrev_b32 v116, 16, v230
    v_and_b32 v117, s48, v230
    v_lshlrev_b32 v118, 16, v231
    v_and_b32 v119, s48, v231
    v_pk_mul_f32 v[112:113], v[112:113], s[40:41]
    v_pk_mul_f32 v[114:115], v[114:115], s[40:41]
    v_pk_mul_f32 v[116:117], v[116:117], s[40:41]
    v_pk_mul_f32 v[118:119], v[118:119], s[40:41]
    v_cvt_pk_bf16_f32 v228, v112, v113
    v_cvt_pk_bf16_f32 v229, v114, v115
    v_cvt_pk_bf16_f32 v230, v116, v117
    v_cvt_pk_bf16_f32 v231, v118, v119
    v_lshlrev_b32 v112, 16, v232
    v_and_b32 v113, s48, v232
    v_lshlrev_b32 v114, 16, v233
    v_and_b32 v115, s48, v233
    v_lshlrev_b32 v116, 16, v234
    v_and_b32 v117, s48, v234
    v_lshlrev_b32 v118, 16, v235
    v_and_b32 v119, s48, v235
    v_pk_mul_f32 v[112:113], v[112:113], s[40:41]
    v_pk_mul_f32 v[114:115], v[114:115], s[40:41]
    v_pk_mul_f32 v[116:117], v[116:117], s[40:41]
    v_pk_mul_f32 v[118:119], v[118:119], s[40:41]
    v_cvt_pk_bf16_f32 v232, v112, v113
    v_cvt_pk_bf16_f32 v233, v114, v115
    v_cvt_pk_bf16_f32 v234, v116, v117
    v_cvt_pk_bf16_f32 v235, v118, v119
    v_lshlrev_b32 v112, 16, v236
    v_and_b32 v113, s48, v236
    v_lshlrev_b32 v114, 16, v237
    v_and_b32 v115, s48, v237
    v_lshlrev_b32 v116, 16, v238
    v_and_b32 v117, s48, v238
    v_lshlrev_b32 v118, 16, v239
    v_and_b32 v119, s48, v239
    v_pk_mul_f32 v[112:113], v[112:113], s[40:41]
    v_pk_mul_f32 v[114:115], v[114:115], s[40:41]
    v_pk_mul_f32 v[116:117], v[116:117], s[40:41]
    v_pk_mul_f32 v[118:119], v[118:119], s[40:41]
    v_cvt_pk_bf16_f32 v236, v112, v113
    v_cvt_pk_bf16_f32 v237, v114, v115
    v_cvt_pk_bf16_f32 v238, v116, v117
    v_cvt_pk_bf16_f32 v239, v118, v119
    v_lshlrev_b32 v112, 16, v240
    v_and_b32 v113, s48, v240
    v_lshlrev_b32 v114, 16, v241
    v_and_b32 v115, s48, v241
    v_lshlrev_b32 v116, 16, v242
    v_and_b32 v117, s48, v242
    v_lshlrev_b32 v118, 16, v243
    v_and_b32 v119, s48, v243
    v_pk_mul_f32 v[112:113], v[112:113], s[40:41]
    v_pk_mul_f32 v[114:115], v[114:115], s[40:41]
    v_pk_mul_f32 v[116:117], v[116:117], s[40:41]
    v_pk_mul_f32 v[118:119], v[118:119], s[40:41]
    v_cvt_pk_bf16_f32 v240, v112, v113
    v_cvt_pk_bf16_f32 v241, v114, v115
    v_cvt_pk_bf16_f32 v242, v116, v117
    v_cvt_pk_bf16_f32 v243, v118, v119
    v_lshlrev_b32 v112, 16, v244
    v_and_b32 v113, s48, v244
    v_lshlrev_b32 v114, 16, v245
    v_and_b32 v115, s48, v245
    v_lshlrev_b32 v116, 16, v246
    v_and_b32 v117, s48, v246
    v_lshlrev_b32 v118, 16, v247
    v_and_b32 v119, s48, v247
    v_pk_mul_f32 v[112:113], v[112:113], s[40:41]
    v_pk_mul_f32 v[114:115], v[114:115], s[40:41]
    v_pk_mul_f32 v[116:117], v[116:117], s[40:41]
    v_pk_mul_f32 v[118:119], v[118:119], s[40:41]
    v_cvt_pk_bf16_f32 v244, v112, v113
    v_cvt_pk_bf16_f32 v245, v114, v115
    v_cvt_pk_bf16_f32 v246, v116, v117
    v_cvt_pk_bf16_f32 v247, v118, v119
    v_lshlrev_b32 v112, 16, v248
    v_and_b32 v113, s48, v248
    v_lshlrev_b32 v114, 16, v249
    v_and_b32 v115, s48, v249
    v_lshlrev_b32 v116, 16, v250
    v_and_b32 v117, s48, v250
    v_lshlrev_b32 v118, 16, v251
    v_and_b32 v119, s48, v251
    v_pk_mul_f32 v[112:113], v[112:113], s[40:41]
    v_pk_mul_f32 v[114:115], v[114:115], s[40:41]
    v_pk_mul_f32 v[116:117], v[116:117], s[40:41]
    v_pk_mul_f32 v[118:119], v[118:119], s[40:41]
    v_cvt_pk_bf16_f32 v248, v112, v113
    v_cvt_pk_bf16_f32 v249, v114, v115
    v_cvt_pk_bf16_f32 v250, v116, v117
    v_cvt_pk_bf16_f32 v251, v118, v119
    v_lshlrev_b32 v112, 16, v252
    v_and_b32 v113, s48, v252
    v_lshlrev_b32 v114, 16, v253
    v_and_b32 v115, s48, v253
    v_lshlrev_b32 v116, 16, v254
    v_and_b32 v117, s48, v254
    v_lshlrev_b32 v118, 16, v255
    v_and_b32 v119, s48, v255
    v_pk_mul_f32 v[112:113], v[112:113], s[40:41]
    v_pk_mul_f32 v[114:115], v[114:115], s[40:41]
    v_pk_mul_f32 v[116:117], v[116:117], s[40:41]
    v_pk_mul_f32 v[118:119], v[118:119], s[40:41]
    v_cvt_pk_bf16_f32 v252, v112, v113
    v_cvt_pk_bf16_f32 v253, v114, v115
    v_cvt_pk_bf16_f32 v254, v116, v117
    v_cvt_pk_bf16_f32 v255, v118, v119
    v_mov_b32 v124, 0xff800000
    v_mov_b32 v125, 0xff800000
    v_mov_b32 v126, 0xff800000
    v_mov_b32 v127, 0xff800000
    v_mov_b32 v128, 0xff800000
    v_mov_b32 v129, 0xff800000
    v_mov_b32 v5, v3
    s_mov_b32 s46, 0
L_fb_loop:
    s_barrier
    s_add_u32 m0, s36, 0
    s_nop 0
    buffer_load_dwordx4 v2, s[20:23], s46 offen offset:0 nt lds
    s_add_u32 m0, s36, 800
    s_nop 0
    buffer_load_dwordx4 v2, s[20:23], s46 offen offset:256 nt lds
    s_waitcnt vmcnt(0)
    s_barrier
    ds_read_b128 v[136:139], v5 offset:0
    ds_read_b128 v[140:143], v5 offset:64
    ds_read_b128 v[144:147], v5 offset:128
    ds_read_b128 v[148:151], v5 offset:192
    ds_read_b128 a[160:163], v5 offset:512
    ds_read_b128 a[164:167], v5 offset:576
    ds_read_b128 a[168:171], v5 offset:640
    ds_read_b128 a[172:175], v5 offset:704
    s_waitcnt lgkmcnt(0)
    v_mfma_f32_16x16x32_bf16 v[40:43], v[136:139], v[160:163], 0
    v_mfma_f32_16x16x32_bf16 v[40:43], v[140:143], v[164:167], v[40:43]
    v_mfma_f32_16x16x32_bf16 v[40:43], v[144:147], v[168:171], v[40:43]
    v_mfma_f32_16x16x32_bf16 v[40:43], v[148:151], v[172:175], v[40:43]
    v_mfma_f32_16x16x32_bf16 v[64:67], a[160:163], v[160:163], 0
    v_mfma_f32_16x16x32_bf16 v[64:67], a[164:167], v[164:167], v[64:67]
    v_mfma_f32_16x16x32_bf16 v[64:67], a[168:171], v[168:171], v[64:67]
    v_mfma_f32_16x16x32_bf16 v[64:67], a[172:175], v[172:175], v[64:67]
    v_mfma_f32_16x16x32_bf16 v[44:47], v[136:139], v[176:179], 0
    v_mfma_f32_16x16x32_bf16 v[44:47], v[140:143], v[180:183], v[44:47]
    v_mfma_f32_16x16x32_bf16 v[44:47], v[144:147], v[184:187], v[44:47]
    v_mfma_f32_16x16x32_bf16 v[44:47], v[148:151], v[188:191], v[44:47]
    v_mfma_f32_16x16x32_bf16 v[68:71], a[160:163], v[176:179], 0
    v_mfma_f32_16x16x32_bf16 v[68:71], a[164:167], v[180:183], v[68:71]
    v_mfma_f32_16x16x32_bf16 v[68:71], a[168:171], v[184:187], v[68:71]
    v_mfma_f32_16x16x32_bf16 v[68:71], a[172:175], v[188:191], v[68:71]
    v_mfma_f32_16x16x32_bf16 v[48:51], v[136:139], v[192:195], 0
    v_mfma_f32_16x16x32_bf16 v[48:51], v[140:143], v[196:199], v[48:51]
    v_mfma_f32_16x16x32_bf16 v[48:51], v[144:147], v[200:203], v[48:51]
    v_mfma_f32_16x16x32_bf16 v[48:51], v[148:151], v[204:207], v[48:51]
    v_mfma_f32_16x16x32_bf16 v[72:75], a[160:163], v[192:195], 0
    v_mfma_f32_16x16x32_bf16 v[72:75], a[164:167], v[196:199], v[72:75]
    v_mfma_f32_16x16x32_bf16 v[72:75], a[168:171], v[200:203], v[72:75]
    v_mfma_f32_16x16x32_bf16 v[72:75], a[172:175], v[204:207], v[72:75]
    v_mfma_f32_16x16x32_bf16 v[52:55], v[136:139], v[208:211], 0
    v_mfma_f32_16x16x32_bf16 v[52:55], v[140:143], v[212:215], v[52:55]
    v_mfma_f32_16x16x32_bf16 v[52:55], v[144:147], v[216:219], v[52:55]
    v_mfma_f32_16x16x32_bf16 v[52:55], v[148:151], v[220:223], v[52:55]
    v_mfma_f32_16x16x32_bf16 v[76:79], a[160:163], v[208:211], 0
    v_mfma_f32_16x16x32_bf16 v[76:79], a[164:167], v[212:215], v[76:79]
    v_mfma_f32_16x16x32_bf16 v[76:79], a[168:171], v[216:219], v[76:79]
    v_mfma_f32_16x16x32_bf16 v[76:79], a[172:175], v[220:223], v[76:79]
    v_mfma_f32_16x16x32_bf16 v[56:59], v[136:139], v[224:227], 0
    v_mfma_f32_16x16x32_bf16 v[56:59], v[140:143], v[228:231], v[56:59]
    v_mfma_f32_16x16x32_bf16 v[56:59], v[144:147], v[232:235], v[56:59]
    v_mfma_f32_16x16x32_bf16 v[56:59], v[148:151], v[236:239], v[56:59]
    v_mfma_f32_16x16x32_bf16 v[80:83], a[160:163], v[224:227], 0
    v_mfma_f32_16x16x32_bf16 v[80:83], a[164:167], v[228:231], v[80:83]
    v_mfma_f32_16x16x32_bf16 v[80:83], a[168:171], v[232:235], v[80:83]
    v_mfma_f32_16x16x32_bf16 v[80:83], a[172:175], v[236:239], v[80:83]
    v_mfma_f32_16x16x32_bf16 v[60:63], v[136:139], v[240:243], 0
    v_mfma_f32_16x16x32_bf16 v[60:63], v[140:143], v[244:247], v[60:63]
    v_mfma_f32_16x16x32_bf16 v[60:63], v[144:147], v[248:251], v[60:63]
    v_mfma_f32_16x16x32_bf16 v[60:63], v[148:151], v[252:255], v[60:63]
    v_mfma_f32_16x16x32_bf16 v[84:87], a[160:163], v[240:243], 0
    v_mfma_f32_16x16x32_bf16 v[84:87], a[164:167], v[244:247], v[84:87]
    v_mfma_f32_16x16x32_bf16 v[84:87], a[168:171], v[248:251], v[84:87]
    v_mfma_f32_16x16x32_bf16 v[84:87], a[172:175], v[252:255], v[84:87]
    s_nop 7
    v_max3_f32 v124, v124, v40, v41
    v_max3_f32 v124, v124, v42, v43
    v_max3_f32 v124, v124, v64, v65
    v_max3_f32 v124, v124, v66, v67
    v_max3_f32 v125, v125, v44, v45
    v_max3_f32 v125, v125, v46, v47
    v_max3_f32 v125, v125, v68, v69
    v_max3_f32 v125, v125, v70, v71
    v_max3_f32 v126, v126, v48, v49
    v_max3_f32 v126, v126, v50, v51
    v_max3_f32 v126, v126, v72, v73
    v_max3_f32 v126, v126, v74, v75
    v_max3_f32 v127, v127, v52, v53
    v_max3_f32 v127, v127, v54, v55
    v_max3_f32 v127, v127, v76, v77
    v_max3_f32 v127, v127, v78, v79
    v_max3_f32 v128, v128, v56, v57
    v_max3_f32 v128, v128, v58, v59
    v_max3_f32 v128, v128, v80, v81
    v_max3_f32 v128, v128, v82, v83
    v_max3_f32 v129, v129, v60, v61
    v_max3_f32 v129, v129, v62, v63
    v_max3_f32 v129, v129, v84, v85
    v_max3_f32 v129, v129, v86, v87
    s_add_u32 s46, s46, 8192
    s_cmp_lt_u32 s46, 262144
    s_cbranch_scc1 L_fb_loop
    v_mov_b32 v154, v124
    s_nop 1
    v_permlane16_swap_b32 v124, v154
    v_max_f32 v124, v124, v154
    v_mov_b32 v154, v124
    s_nop 1
    v_permlane32_swap_b32 v124, v154
    v_max_f32 v124, v124, v154
    v_sub_f32 v16, 0, v124
    v_sub_f32 v17, 0, v124
    v_sub_f32 v18, 0, v124
    v_sub_f32 v19, 0, v124
    v_mov_b32 v154, v125
    s_nop 1
    v_permlane16_swap_b32 v125, v154
    v_max_f32 v125, v125, v154
    v_mov_b32 v154, v125
    s_nop 1
    v_permlane32_swap_b32 v125, v154
    v_max_f32 v125, v125, v154
    v_sub_f32 v20, 0, v125
    v_sub_f32 v21, 0, v125
    v_sub_f32 v22, 0, v125
    v_sub_f32 v23, 0, v125
    v_mov_b32 v154, v126
    s_nop 1
    v_permlane16_swap_b32 v126, v154
    v_max_f32 v126, v126, v154
    v_mov_b32 v154, v126
    s_nop 1
    v_permlane32_swap_b32 v126, v154
    v_max_f32 v126, v126, v154
    v_sub_f32 v24, 0, v126
    v_sub_f32 v25, 0, v126
    v_sub_f32 v26, 0, v126
    v_sub_f32 v27, 0, v126
    v_mov_b32 v154, v127
    s_nop 1
    v_permlane16_swap_b32 v127, v154
    v_max_f32 v127, v127, v154
    v_mov_b32 v154, v127
    s_nop 1
    v_permlane32_swap_b32 v127, v154
    v_max_f32 v127, v127, v154
    v_sub_f32 v28, 0, v127
    v_sub_f32 v29, 0, v127
    v_sub_f32 v30, 0, v127
    v_sub_f32 v31, 0, v127
    v_mov_b32 v154, v128
    s_nop 1
    v_permlane16_swap_b32 v128, v154
    v_max_f32 v128, v128, v154
    v_mov_b32 v154, v128
    s_nop 1
    v_permlane32_swap_b32 v128, v154
    v_max_f32 v128, v128, v154
    v_sub_f32 v32, 0, v128
    v_sub_f32 v33, 0, v128
    v_sub_f32 v34, 0, v128
    v_sub_f32 v35, 0, v128
    v_mov_b32 v154, v129
    s_nop 1
    v_permlane16_swap_b32 v129, v154
    v_max_f32 v129, v129, v154
    v_mov_b32 v154, v129
    s_nop 1
    v_permlane32_swap_b32 v129, v154
    v_max_f32 v129, v129, v154
    v_sub_f32 v36, 0, v129
    v_sub_f32 v37, 0, v129
    v_sub_f32 v38, 0, v129
    v_sub_f32 v39, 0, v129
    s_barrier
    s_add_u32 s42, s3, 0
    s_and_b32 s42, s42, 0x3ffff
    s_add_u32 m0, s36, 0
    s_nop 0
    buffer_load_dwordx4 v2, s[20:23], s42 offen offset:0 nt lds
    s_add_u32 m0, s36, 800
    s_nop 0
    buffer_load_dwordx4 v2, s[20:23], s42 offen offset:256 nt lds
    s_add_u32 s42, s3, 8192
    s_and_b32 s42, s42, 0x3ffff
    s_add_u32 m0, s36, 8448
    s_nop 0
    buffer_load_dwordx4 v2, s[20:23], s42 offen offset:0 nt lds
    s_add_u32 m0, s36, 9248
    s_nop 0
    buffer_load_dwordx4 v2, s[20:23], s42 offen offset:256 nt lds
    s_add_u32 s42, s3, 16384
    s_and_b32 s42, s42, 0x3ffff
    s_add_u32 m0, s36, 16896
    s_nop 0
    buffer_load_dwordx4 v2, s[20:23], s42 offen offset:0 nt lds
    s_add_u32 m0, s36, 17696
    s_nop 0
    buffer_load_dwordx4 v2, s[20:23], s42 offen offset:256 nt lds
    s_add_u32 s42, s3, 0
    s_and_b32 s42, s42, 0x3ffff
    s_add_u32 m0, s37, 0
    s_nop 0
    buffer_load_dwordx4 v2, s[24:27], s42 offen offset:0 nt lds
    s_add_u32 m0, s37, 800
    s_nop 0
    buffer_load_dwordx4 v2, s[24:27], s42 offen offset:256 nt lds
    s_add_u32 s42, s3, 8192
    s_and_b32 s42, s42, 0x3ffff
    s_add_u32 m0, s37, 8448
    s_nop 0
    buffer_load_dwordx4 v2, s[24:27], s42 offen offset:0 nt lds
    s_add_u32 m0, s37, 9248
    s_nop 0
    buffer_load_dwordx4 v2, s[24:27], s42 offen offset:256 nt lds
    v_mov_b32 v156, 0
    v_mov_b32 v157, 0
    v_mov_b32 v158, 0
    v_mov_b32 v159, 0
    v_mov_b32 v8, 0
    v_mov_b32 v9, 0
    v_mov_b32 v10, 0
    v_mov_b32 v11, 0
    v_mov_b32 v12, 0
    v_mov_b32 v13, 0
    s_mov_b32 s51, 16896
    s_mov_b32 s52, 15
    v_mfma_f32_32x32x16_bf16 a[96:111], v[156:159], v[156:159], 0
    v_mfma_f32_32x32x16_bf16 a[112:127], v[156:159], v[156:159], 0
    v_mfma_f32_32x32x16_bf16 a[128:143], v[156:159], v[156:159], 0
    v_mfma_f32_32x32x16_bf16 a[144:159], v[156:159], v[156:159], 0
    v_mov_b32 v5, v3
    v_mov_b32 v6, v4
    s_waitcnt vmcnt(0)
    s_barrier
    ds_read_b128 v[136:139], v5 offset:0
    ds_read_b128 v[140:143], v5 offset:64
    ds_read_b128 v[144:147], v5 offset:128
    ds_read_b128 v[148:151], v5 offset:192
    ds_read_b128 a[160:163], v5 offset:512
    ds_read_b128 a[164:167], v5 offset:576
    ds_read_b128 a[168:171], v5 offset:640
    ds_read_b128 a[172:175], v5 offset:704
    ds_read_b128 a[224:227], v5 offset:8448
    ds_read_b128 a[228:231], v5 offset:8512
    ds_read_b128 a[232:235], v5 offset:8576
    ds_read_b128 a[236:239], v5 offset:8640
    ds_read_b128 a[240:243], v5 offset:8960
    ds_read_b128 a[244:247], v5 offset:9024
    ds_read_b128 a[248:251], v5 offset:9088
    ds_read_b128 a[252:255], v5 offset:9152
    ds_read_b64_tr_b16 a[192:193], v6 offset:0
    ds_read_b64_tr_b16 a[194:195], v6 offset:512
    ds_read_b64_tr_b16 a[196:197], v6 offset:32
    ds_read_b64_tr_b16 a[198:199], v6 offset:544
    ds_read_b64_tr_b16 a[200:201], v6 offset:64
    ds_read_b64_tr_b16 a[202:203], v6 offset:576
    ds_read_b64_tr_b16 a[204:205], v6 offset:96
    ds_read_b64_tr_b16 a[206:207], v6 offset:608
    ds_read_b64_tr_b16 a[208:209], v6 offset:128
    ds_read_b64_tr_b16 a[210:211], v6 offset:640
    ds_read_b64_tr_b16 a[212:213], v6 offset:160
    ds_read_b64_tr_b16 a[214:215], v6 offset:672
    ds_read_b64_tr_b16 a[216:217], v6 offset:192
    ds_read_b64_tr_b16 a[218:219], v6 offset:704
    ds_read_b64_tr_b16 a[220:221], v6 offset:224
    ds_read_b64_tr_b16 a[222:223], v6 offset:736
    v_add_u32 v5, 16896, v3
    s_waitcnt lgkmcnt(0)
    v_mfma_f32_16x16x32_bf16 v[112:115], v[136:139], v[160:163], v[16:19]
    v_mfma_f32_16x16x32_bf16 v[112:115], v[140:143], v[164:167], v[112:115]
    v_mfma_f32_16x16x32_bf16 v[112:115], v[144:147], v[168:171], v[112:115]
    v_mfma_f32_16x16x32_bf16 v[112:115], v[148:151], v[172:175], v[112:115]
    v_mfma_f32_16x16x32_bf16 v[116:119], a[160:163], v[160:163], v[16:19]
    v_mfma_f32_16x16x32_bf16 v[116:119], a[164:167], v[164:167], v[116:119]
    v_mfma_f32_16x16x32_bf16 v[116:119], a[168:171], v[168:171], v[116:119]
    v_mfma_f32_16x16x32_bf16 v[116:119], a[172:175], v[172:175], v[116:119]
    s_nop 7
    v_mfma_f32_16x16x32_bf16 v[40:43], a[224:227], v[160:163], v[16:19]
    v_exp_f32 v112, v112
    v_mfma_f32_16x16x32_bf16 v[40:43], a[228:231], v[164:167], v[40:43]
    v_exp_f32 v113, v113
    v_mfma_f32_16x16x32_bf16 v[40:43], a[232:235], v[168:171], v[40:43]
    v_exp_f32 v114, v114
    v_mfma_f32_16x16x32_bf16 v[40:43], a[236:239], v[172:175], v[40:43]
    v_exp_f32 v115, v115
    v_mfma_f32_16x16x32_bf16 v[64:67], a[240:243], v[160:163], v[16:19]
    v_exp_f32 v116, v116
    v_mfma_f32_16x16x32_bf16 v[64:67], a[244:247], v[164:167], v[64:67]
    v_exp_f32 v117, v117
    v_mfma_f32_16x16x32_bf16 v[64:67], a[248:251], v[168:171], v[64:67]
    v_exp_f32 v118, v118
    v_mfma_f32_16x16x32_bf16 v[64:67], a[252:255], v[172:175], v[64:67]
    v_exp_f32 v119, v119
    v_cvt_pk_bf16_f32 v88, v112, v113
    v_cvt_pk_bf16_f32 v89, v114, v115
    v_cvt_pk_bf16_f32 v90, v116, v117
    v_cvt_pk_bf16_f32 v91, v118, v119
    v_add_f32 v8, v8, v112
    v_add_f32 v8, v8, v113
    v_mfma_f32_16x16x32_bf16 a[0:3], a[192:195], v[88:91], 0
    v_exp_f32 v40, v40
    v_mfma_f32_16x16x32_bf16 a[4:7], a[196:199], v[88:91], 0
    v_exp_f32 v41, v41
    v_mfma_f32_16x16x32_bf16 a[8:11], a[200:203], v[88:91], 0
    v_exp_f32 v42, v42
    v_mfma_f32_16x16x32_bf16 a[12:15], a[204:207], v[88:91], 0
    v_exp_f32 v43, v43
    v_mfma_f32_16x16x32_bf16 a[16:19], a[208:211], v[88:91], 0
    v_add_f32 v8, v8, v114
    v_add_f32 v8, v8, v115
    v_mfma_f32_16x16x32_bf16 a[20:23], a[212:215], v[88:91], 0
    v_add_f32 v8, v8, v116
    v_add_f32 v8, v8, v117
    v_mfma_f32_16x16x32_bf16 a[24:27], a[216:219], v[88:91], 0
    v_add_f32 v8, v8, v118
    v_add_f32 v8, v8, v119
    v_mfma_f32_16x16x32_bf16 a[28:31], a[220:223], v[88:91], 0
    v_add_f32 v8, v8, v40
    v_add_f32 v8, v8, v41
    v_add_f32 v8, v8, v42
    v_add_f32 v8, v8, v43
    v_mfma_f32_16x16x32_bf16 v[112:115], v[136:139], v[176:179], v[20:23]
    v_mfma_f32_16x16x32_bf16 v[112:115], v[140:143], v[180:183], v[112:115]
    v_mfma_f32_16x16x32_bf16 v[112:115], v[144:147], v[184:187], v[112:115]
    v_mfma_f32_16x16x32_bf16 v[112:115], v[148:151], v[188:191], v[112:115]
    v_mfma_f32_16x16x32_bf16 v[116:119], a[160:163], v[176:179], v[20:23]
    v_mfma_f32_16x16x32_bf16 v[116:119], a[164:167], v[180:183], v[116:119]
    v_mfma_f32_16x16x32_bf16 v[116:119], a[168:171], v[184:187], v[116:119]
    v_mfma_f32_16x16x32_bf16 v[116:119], a[172:175], v[188:191], v[116:119]
    s_nop 7
    v_mfma_f32_16x16x32_bf16 v[44:47], a[224:227], v[176:179], v[20:23]
    v_exp_f32 v112, v112
    v_mfma_f32_16x16x32_bf16 v[44:47], a[228:231], v[180:183], v[44:47]
    v_exp_f32 v113, v113
    v_mfma_f32_16x16x32_bf16 v[44:47], a[232:235], v[184:187], v[44:47]
    v_exp_f32 v114, v114
    v_mfma_f32_16x16x32_bf16 v[44:47], a[236:239], v[188:191], v[44:47]
    v_exp_f32 v115, v115
    v_mfma_f32_16x16x32_bf16 v[68:71], a[240:243], v[176:179], v[20:23]
    v_exp_f32 v116, v116
    v_mfma_f32_16x16x32_bf16 v[68:71], a[244:247], v[180:183], v[68:71]
    v_exp_f32 v117, v117
    v_mfma_f32_16x16x32_bf16 v[68:71], a[248:251], v[184:187], v[68:71]
    v_exp_f32 v118, v118
    v_mfma_f32_16x16x32_bf16 v[68:71], a[252:255], v[188:191], v[68:71]
    v_exp_f32 v119, v119
    v_cvt_pk_bf16_f32 v92, v112, v113
    v_cvt_pk_bf16_f32 v93, v114, v115
    v_cvt_pk_bf16_f32 v94, v116, v117
    v_cvt_pk_bf16_f32 v95, v118, v119
    v_add_f32 v9, v9, v112
    v_add_f32 v9, v9, v113
    v_mfma_f32_16x16x32_bf16 a[32:35], a[192:195], v[92:95], 0
    v_exp_f32 v44, v44
    v_mfma_f32_16x16x32_bf16 a[36:39], a[196:199], v[92:95], 0
    v_exp_f32 v45, v45
    v_mfma_f32_16x16x32_bf16 a[40:43], a[200:203], v[92:95], 0
    v_exp_f32 v46, v46
    v_mfma_f32_16x16x32_bf16 a[44:47], a[204:207], v[92:95], 0
    v_exp_f32 v47, v47
    v_mfma_f32_16x16x32_bf16 a[48:51], a[208:211], v[92:95], 0
    v_add_f32 v9, v9, v114
    v_add_f32 v9, v9, v115
    v_mfma_f32_16x16x32_bf16 a[52:55], a[212:215], v[92:95], 0
    v_add_f32 v9, v9, v116
    v_add_f32 v9, v9, v117
    v_mfma_f32_16x16x32_bf16 a[56:59], a[216:219], v[92:95], 0
    v_add_f32 v9, v9, v118
    v_add_f32 v9, v9, v119
    v_mfma_f32_16x16x32_bf16 a[60:63], a[220:223], v[92:95], 0
    v_add_f32 v9, v9, v44
    v_add_f32 v9, v9, v45
    v_add_f32 v9, v9, v46
    v_add_f32 v9, v9, v47
    v_mfma_f32_16x16x32_bf16 v[112:115], v[136:139], v[192:195], v[24:27]
    v_mfma_f32_16x16x32_bf16 v[112:115], v[140:143], v[196:199], v[112:115]
    v_mfma_f32_16x16x32_bf16 v[112:115], v[144:147], v[200:203], v[112:115]
    v_mfma_f32_16x16x32_bf16 v[112:115], v[148:151], v[204:207], v[112:115]
    v_mfma_f32_16x16x32_bf16 v[116:119], a[160:163], v[192:195], v[24:27]
    v_mfma_f32_16x16x32_bf16 v[116:119], a[164:167], v[196:199], v[116:119]
    v_mfma_f32_16x16x32_bf16 v[116:119], a[168:171], v[200:203], v[116:119]
    v_mfma_f32_16x16x32_bf16 v[116:119], a[172:175], v[204:207], v[116:119]
    s_nop 7
    v_mfma_f32_16x16x32_bf16 v[48:51], a[224:227], v[192:195], v[24:27]
    v_exp_f32 v112, v112
    v_mfma_f32_16x16x32_bf16 v[48:51], a[228:231], v[196:199], v[48:51]
    v_exp_f32 v113, v113
    v_mfma_f32_16x16x32_bf16 v[48:51], a[232:235], v[200:203], v[48:51]
    v_exp_f32 v114, v114
    v_mfma_f32_16x16x32_bf16 v[48:51], a[236:239], v[204:207], v[48:51]
    v_exp_f32 v115, v115
    v_mfma_f32_16x16x32_bf16 v[72:75], a[240:243], v[192:195], v[24:27]
    v_exp_f32 v116, v116
    v_mfma_f32_16x16x32_bf16 v[72:75], a[244:247], v[196:199], v[72:75]
    v_exp_f32 v117, v117
    v_mfma_f32_16x16x32_bf16 v[72:75], a[248:251], v[200:203], v[72:75]
    v_exp_f32 v118, v118
    v_mfma_f32_16x16x32_bf16 v[72:75], a[252:255], v[204:207], v[72:75]
    v_exp_f32 v119, v119
    v_cvt_pk_bf16_f32 v96, v112, v113
    v_cvt_pk_bf16_f32 v97, v114, v115
    v_cvt_pk_bf16_f32 v98, v116, v117
    v_cvt_pk_bf16_f32 v99, v118, v119
    v_add_f32 v10, v10, v112
    v_add_f32 v10, v10, v113
    v_mfma_f32_16x16x32_bf16 a[64:67], a[192:195], v[96:99], 0
    v_exp_f32 v48, v48
    v_mfma_f32_16x16x32_bf16 a[68:71], a[196:199], v[96:99], 0
    v_exp_f32 v49, v49
    v_mfma_f32_16x16x32_bf16 a[72:75], a[200:203], v[96:99], 0
    v_exp_f32 v50, v50
    v_mfma_f32_16x16x32_bf16 a[76:79], a[204:207], v[96:99], 0
    v_exp_f32 v51, v51
    v_mfma_f32_16x16x32_bf16 a[80:83], a[208:211], v[96:99], 0
    v_add_f32 v10, v10, v114
    v_add_f32 v10, v10, v115
    v_mfma_f32_16x16x32_bf16 a[84:87], a[212:215], v[96:99], 0
    v_add_f32 v10, v10, v116
    v_add_f32 v10, v10, v117
    v_mfma_f32_16x16x32_bf16 a[88:91], a[216:219], v[96:99], 0
    v_add_f32 v10, v10, v118
    v_add_f32 v10, v10, v119
    v_mfma_f32_16x16x32_bf16 a[92:95], a[220:223], v[96:99], 0
    v_add_f32 v10, v10, v48
    v_add_f32 v10, v10, v49
    v_add_f32 v10, v10, v50
    v_add_f32 v10, v10, v51
    v_mfma_f32_16x16x32_bf16 v[112:115], v[136:139], v[208:211], v[28:31]
    v_mfma_f32_16x16x32_bf16 v[112:115], v[140:143], v[212:215], v[112:115]
    v_mfma_f32_16x16x32_bf16 v[112:115], v[144:147], v[216:219], v[112:115]
    v_mfma_f32_16x16x32_bf16 v[112:115], v[148:151], v[220:223], v[112:115]
    v_mfma_f32_16x16x32_bf16 v[116:119], a[160:163], v[208:211], v[28:31]
    v_mfma_f32_16x16x32_bf16 v[116:119], a[164:167], v[212:215], v[116:119]
    v_mfma_f32_16x16x32_bf16 v[116:119], a[168:171], v[216:219], v[116:119]
    v_mfma_f32_16x16x32_bf16 v[116:119], a[172:175], v[220:223], v[116:119]
    s_nop 7
    v_mfma_f32_16x16x32_bf16 v[52:55], a[224:227], v[208:211], v[28:31]
    v_exp_f32 v112, v112
    v_mfma_f32_16x16x32_bf16 v[52:55], a[228:231], v[212:215], v[52:55]
    v_exp_f32 v113, v113
    v_mfma_f32_16x16x32_bf16 v[52:55], a[232:235], v[216:219], v[52:55]
    v_exp_f32 v114, v114
    v_mfma_f32_16x16x32_bf16 v[52:55], a[236:239], v[220:223], v[52:55]
    v_exp_f32 v115, v115
    v_mfma_f32_16x16x32_bf16 v[76:79], a[240:243], v[208:211], v[28:31]
    v_exp_f32 v116, v116
    v_mfma_f32_16x16x32_bf16 v[76:79], a[244:247], v[212:215], v[76:79]
    v_exp_f32 v117, v117
    v_mfma_f32_16x16x32_bf16 v[76:79], a[248:251], v[216:219], v[76:79]
    v_exp_f32 v118, v118
    v_mfma_f32_16x16x32_bf16 v[76:79], a[252:255], v[220:223], v[76:79]
    v_exp_f32 v119, v119
    v_cvt_pk_bf16_f32 v100, v112, v113
    v_cvt_pk_bf16_f32 v101, v114, v115
    v_cvt_pk_bf16_f32 v102, v116, v117
    v_cvt_pk_bf16_f32 v103, v118, v119
    v_add_f32 v11, v11, v112
    v_add_f32 v11, v11, v113
    v_add_f32 v11, v11, v114
    v_add_f32 v11, v11, v115
    v_add_f32 v11, v11, v116
    v_add_f32 v11, v11, v117
    v_add_f32 v11, v11, v118
    v_add_f32 v11, v11, v119
    v_exp_f32 v52, v52
    v_exp_f32 v53, v53
    v_exp_f32 v54, v54
    v_exp_f32 v55, v55
    v_exp_f32 v76, v76
    v_exp_f32 v77, v77
    v_exp_f32 v78, v78
    v_exp_f32 v79, v79
    v_cvt_pk_bf16_f32 v124, v52, v53
    v_cvt_pk_bf16_f32 v125, v54, v55
    v_cvt_pk_bf16_f32 v126, v76, v77
    v_cvt_pk_bf16_f32 v127, v78, v79
    v_add_f32 v11, v11, v52
    v_add_f32 v11, v11, v53
    v_add_f32 v11, v11, v54
    v_add_f32 v11, v11, v55
    v_add_f32 v11, v11, v76
    v_add_f32 v11, v11, v77
    v_add_f32 v11, v11, v78
    v_add_f32 v11, v11, v79
    v_mfma_f32_16x16x32_bf16 v[112:115], v[136:139], v[224:227], v[32:35]
    v_mfma_f32_16x16x32_bf16 v[112:115], v[140:143], v[228:231], v[112:115]
    v_mfma_f32_16x16x32_bf16 v[112:115], v[144:147], v[232:235], v[112:115]
    v_mfma_f32_16x16x32_bf16 v[112:115], v[148:151], v[236:239], v[112:115]
    v_mfma_f32_16x16x32_bf16 v[116:119], a[160:163], v[224:227], v[32:35]
    v_mfma_f32_16x16x32_bf16 v[116:119], a[164:167], v[228:231], v[116:119]
    v_mfma_f32_16x16x32_bf16 v[116:119], a[168:171], v[232:235], v[116:119]
    v_mfma_f32_16x16x32_bf16 v[116:119], a[172:175], v[236:239], v[116:119]
    s_nop 7
    v_mfma_f32_16x16x32_bf16 v[56:59], a[224:227], v[224:227], v[32:35]
    v_exp_f32 v112, v112
    v_mfma_f32_16x16x32_bf16 v[56:59], a[228:231], v[228:231], v[56:59]
    v_exp_f32 v113, v113
    v_mfma_f32_16x16x32_bf16 v[56:59], a[232:235], v[232:235], v[56:59]
    v_exp_f32 v114, v114
    v_mfma_f32_16x16x32_bf16 v[56:59], a[236:239], v[236:239], v[56:59]
    v_exp_f32 v115, v115
    v_mfma_f32_16x16x32_bf16 v[80:83], a[240:243], v[224:227], v[32:35]
    v_exp_f32 v116, v116
    v_mfma_f32_16x16x32_bf16 v[80:83], a[244:247], v[228:231], v[80:83]
    v_exp_f32 v117, v117
    v_mfma_f32_16x16x32_bf16 v[80:83], a[248:251], v[232:235], v[80:83]
    v_exp_f32 v118, v118
    v_mfma_f32_16x16x32_bf16 v[80:83], a[252:255], v[236:239], v[80:83]
    v_exp_f32 v119, v119
    v_cvt_pk_bf16_f32 v104, v112, v113
    v_cvt_pk_bf16_f32 v105, v114, v115
    v_cvt_pk_bf16_f32 v106, v116, v117
    v_cvt_pk_bf16_f32 v107, v118, v119
    v_add_f32 v12, v12, v112
    v_add_f32 v12, v12, v113
    v_add_f32 v12, v12, v114
    v_add_f32 v12, v12, v115
    v_add_f32 v12, v12, v116
    v_add_f32 v12, v12, v117
    v_add_f32 v12, v12, v118
    v_add_f32 v12, v12, v119
    v_exp_f32 v56, v56
    v_exp_f32 v57, v57
    v_exp_f32 v58, v58
    v_exp_f32 v59, v59
    v_exp_f32 v80, v80
    v_exp_f32 v81, v81
    v_exp_f32 v82, v82
    v_exp_f32 v83, v83
    v_cvt_pk_bf16_f32 v128, v56, v57
    v_cvt_pk_bf16_f32 v129, v58, v59
    v_cvt_pk_bf16_f32 v130, v80, v81
    v_cvt_pk_bf16_f32 v131, v82, v83
    v_add_f32 v12, v12, v56
    v_add_f32 v12, v12, v57
    v_add_f32 v12, v12, v58
    v_add_f32 v12, v12, v59
    v_add_f32 v12, v12, v80
    v_add_f32 v12, v12, v81
    v_add_f32 v12, v12, v82
    v_add_f32 v12, v12, v83
    v_mfma_f32_16x16x32_bf16 v[112:115], v[136:139], v[240:243], v[36:39]
    v_mfma_f32_16x16x32_bf16 v[112:115], v[140:143], v[244:247], v[112:115]
    v_mfma_f32_16x16x32_bf16 v[112:115], v[144:147], v[248:251], v[112:115]
    v_mfma_f32_16x16x32_bf16 v[112:115], v[148:151], v[252:255], v[112:115]
    v_mfma_f32_16x16x32_bf16 v[116:119], a[160:163], v[240:243], v[36:39]
    v_mfma_f32_16x16x32_bf16 v[116:119], a[164:167], v[244:247], v[116:119]
    v_mfma_f32_16x16x32_bf16 v[116:119], a[168:171], v[248:251], v[116:119]
    v_mfma_f32_16x16x32_bf16 v[116:119], a[172:175], v[252:255], v[116:119]
    v_mfma_f32_32x32x16_bf16 a[160:175], v[156:159], v[156:159], 0
    v_mfma_f32_32x32x16_bf16 a[176:191], v[156:159], v[156:159], 0
    s_nop 5
    v_mfma_f32_16x16x32_bf16 v[60:63], a[224:227], v[240:243], v[36:39]
    v_exp_f32 v112, v112
    v_mfma_f32_16x16x32_bf16 v[60:63], a[228:231], v[244:247], v[60:63]
    v_exp_f32 v113, v113
    v_mfma_f32_16x16x32_bf16 v[60:63], a[232:235], v[248:251], v[60:63]
    v_exp_f32 v114, v114
    v_mfma_f32_16x16x32_bf16 v[60:63], a[236:239], v[252:255], v[60:63]
    v_exp_f32 v115, v115
    v_mfma_f32_16x16x32_bf16 v[84:87], a[240:243], v[240:243], v[36:39]
    v_exp_f32 v116, v116
    v_mfma_f32_16x16x32_bf16 v[84:87], a[244:247], v[244:247], v[84:87]
    v_exp_f32 v117, v117
    v_mfma_f32_16x16x32_bf16 v[84:87], a[248:251], v[248:251], v[84:87]
    v_exp_f32 v118, v118
    v_mfma_f32_16x16x32_bf16 v[84:87], a[252:255], v[252:255], v[84:87]
    v_exp_f32 v119, v119
    v_cvt_pk_bf16_f32 v108, v112, v113
    v_cvt_pk_bf16_f32 v109, v114, v115
    v_cvt_pk_bf16_f32 v110, v116, v117
    v_cvt_pk_bf16_f32 v111, v118, v119
    v_add_f32 v13, v13, v112
    v_add_f32 v13, v13, v113
    v_add_f32 v13, v13, v114
    v_add_f32 v13, v13, v115
    v_add_f32 v13, v13, v116
    v_add_f32 v13, v13, v117
    v_add_f32 v13, v13, v118
    v_add_f32 v13, v13, v119
    v_exp_f32 v60, v60
    v_exp_f32 v61, v61
    v_exp_f32 v62, v62
    v_exp_f32 v63, v63
    v_exp_f32 v84, v84
    v_exp_f32 v85, v85
    v_exp_f32 v86, v86
    v_exp_f32 v87, v87
    v_cvt_pk_bf16_f32 v132, v60, v61
    v_cvt_pk_bf16_f32 v133, v62, v63
    v_cvt_pk_bf16_f32 v134, v84, v85
    v_add_f32 v13, v13, v60
    v_add_f32 v13, v13, v61
    v_add_f32 v13, v13, v62
    v_add_f32 v13, v13, v63
    v_add_f32 v13, v13, v84
    v_add_f32 v13, v13, v85
    v_add_f32 v13, v13, v86
    s_cmp_eq_u32 s49, 3
    s_cbranch_scc1 L_lstart
    s_branch L_cstart
.section .rodata,"a"
.p2align 6
.amdhsa_kernel standalone__mha_softmax__near_ridge_kernel
  .amdhsa_next_free_vgpr 512
  .amdhsa_next_free_sgpr 64
  .amdhsa_accum_offset 256
  .amdhsa_group_segment_fixed_size 0
  .amdhsa_kernarg_size 48
  .amdhsa_user_sgpr_count 2
  .amdhsa_user_sgpr_kernarg_segment_ptr 1
  .amdhsa_system_sgpr_workgroup_id_x 1
.end_amdhsa_kernel
```
